```python
import torch

def _softmax(x, axis=-1):
    return torch.softmax(x, dim=axis)
def _gelu(x):
    return torch.nn.functional.gelu(x, approximate="tanh")
def _silu(x):
    return torch.nn.functional.silu(x)
def _sigmoid(x):
    return torch.sigmoid(x)
def _layernorm(x, axis=-1, eps=1e-5):
    m = x.mean(dim=axis, keepdim=True)
    v = x.var(dim=axis, keepdim=True, unbiased=False)
    return (x - m) / torch.sqrt(v + eps)
def _scatter_add(tgt, idx, src, axis=0):
    return tgt.clone().index_add_(axis, idx, src)
def _segment_sum(src, seg, n):
    out = torch.zeros((n,) + src.shape[1:], dtype=src.dtype)
    return out.index_add_(0, seg, src)
def _pad(x, pw):
    flat = tuple(v for pair in reversed(pw) for v in pair)
    return torch.nn.functional.pad(x, flat)

kernel_name = 'gated_mix__ssm_conv_s5__glu_gated_geglu__prompt'

def setup_inputs():

    _w = (lambda a: (lambda t: t.to(torch.bfloat16) if t.is_floating_point() else t)(torch.as_tensor(a)))
    def _A_setup():
        B, S, D = 1, 2048, 448
        P = D
        Lambda_re = -0.5 * (lambda _x: torch.exp(torch.as_tensor(_x)))((lambda *s: torch.randn(*s, dtype=torch.bfloat16) * 0.4)(P))
        Lambda_im = (lambda *s: torch.randn(*s, dtype=torch.bfloat16) * 0.8)(P) * 1.0
        B_re = (lambda *s: torch.randn(*s, dtype=torch.bfloat16) * 0.8)(P, D) * (D ** -0.5)
        B_im = (lambda *s: torch.randn(*s, dtype=torch.bfloat16) * 0.8)(P, D) * (D ** -0.5)
        C_re = (lambda *s: torch.randn(*s, dtype=torch.bfloat16) * 0.8)(D, P) * (P ** -0.5)
        C_im = (lambda *s: torch.randn(*s, dtype=torch.bfloat16) * 0.8)(D, P) * (P ** -0.5)
        log_dt = (lambda *s: torch.randn(*s, dtype=torch.bfloat16) * 0.4)(P) * 0.3 - 2.0
        Dskip = (lambda *s: torch.randn(*s, dtype=torch.bfloat16) * 0.1)(D)
        return {
            "x": _w((lambda *s: torch.randn(*s, dtype=torch.bfloat16) * 0.05)(B, S, D)),
            "Lambda_re": _w(Lambda_re),
            "Lambda_im": _w(Lambda_im),
            "B_re": _w(B_re),
            "B_im": _w(B_im),
            "C_re": _w(C_re),
            "C_im": _w(C_im),
            "log_dt": _w(log_dt),
            "Dskip": _w(Dskip),
        }
    _A_in = _A_setup()

    def _B_setup():
        B, S, Dm, Df = 1, 2048, 448, 1792
        return {
            "x": _w((lambda *s: torch.randn(*s, dtype=torch.bfloat16) * 0.05)(B, S, Dm)),
            "w_gate": _w((lambda *s: torch.randn(*s, dtype=torch.bfloat16) * 3.2)(Dm, Df) * (Dm ** -0.5)),
            "w_up": _w((lambda *s: torch.randn(*s, dtype=torch.bfloat16) * 3.2)(Dm, Df) * (Dm ** -0.5)),
            "w_down": _w((lambda *s: torch.randn(*s, dtype=torch.bfloat16) * 3.2)(Df, Dm) * (Df ** -0.5)),
        }
    _B_in = _B_setup()

    return {
        "A_x": _A_in["x"],
        "A_Lambda_re": _A_in["Lambda_re"],
        "A_Lambda_im": _A_in["Lambda_im"],
        "A_B_re": _A_in["B_re"],
        "A_B_im": _A_in["B_im"],
        "A_C_re": _A_in["C_re"],
        "A_C_im": _A_in["C_im"],
        "A_log_dt": _A_in["log_dt"],
        "A_Dskip": _A_in["Dskip"],
        "B_x": _B_in["x"],
        "B_w_gate": _B_in["w_gate"],
        "B_w_up": _B_in["w_up"],
        "B_w_down": _B_in["w_down"],
        "gate_w": _w((lambda *s: torch.randn(*s, dtype=torch.bfloat16) * 0.05)(448) * 16.0),
    }

def reference(A_x, A_Lambda_re, A_Lambda_im, A_B_re, A_B_im, A_C_re, A_C_im, A_log_dt, A_Dskip, B_x, B_w_gate, B_w_up, B_w_down, gate_w):
    def _A_ref(x, Lambda_re, Lambda_im, B_re, B_im, C_re, C_im, log_dt, Dskip):
        Bsz, L, H = x.shape
        Lam = Lambda_re + 1j * Lambda_im
        Bmat = B_re + 1j * B_im
        Cmat = C_re + 1j * C_im
        dt = torch.exp(log_dt)
        Lam_bar = torch.exp(dt * Lam)
        B_bar = ((Lam_bar - 1.0) / Lam)[:, None] * Bmat
        Bu = torch.einsum("bld,pd->blp", x + 0j, B_bar)
        h = torch.zeros_like(Bu[:, 0, :])
        hs = []
        for t in range(L):
            h = Lam_bar[None, :] * h + Bu[:, t, :]
            hs.append(h)
        hseq = torch.stack(hs, 1)
        y = 2.0 * torch.einsum("blp,dp->bld", hseq, Cmat).real + x * Dskip[None, None, :]
        return y

    def _B_ref(x, w_gate, w_up, w_down):
        g = torch.einsum("bsd,df->bsf", x, w_gate)
        u = torch.einsum("bsd,df->bsf", x, w_up)
        h = _gelu(g) * u
        return torch.einsum("bsf,fd->bsd", h, w_down)

    x = A_x
    g = _sigmoid((x * gate_w).sum(-1, keepdims=True))
    a = _A_ref(x, A_Lambda_re, A_Lambda_im, A_B_re, A_B_im, A_C_re, A_C_im, A_log_dt, A_Dskip)
    b = _B_ref(x, B_w_gate, B_w_up, B_w_down)
    return g * a + (1 - g) * b
```

```asm
; @launch grid=(256,1,1) block=(512,1,1) lds=163840
.amdgcn_target "amdgcn-amd-amdhsa--gfx950"
.text
.globl gated_mix__ssm_conv_s5__glu_gated_geglu__prompt_kernel
.p2align 8
.type gated_mix__ssm_conv_s5__glu_gated_geglu__prompt_kernel,@function
gated_mix__ssm_conv_s5__glu_gated_geglu__prompt_kernel:
    s_cmp_ge_u32 s2, 256
    s_cbranch_scc1 K1_END
    s_add_u32 s2, s2, 224
    s_and_b32 s2, s2, 255
    s_load_dwordx16 s[4:19], s[0:1], 0
    s_load_dwordx16 s[20:35], s[0:1], 64
    s_load_dwordx2 s[36:37], s[0:1], 128
    v_lshrrev_b32 v2, 6, v0
    v_and_b32 v1, 63, v0
    v_readfirstlane_b32 s64, v2
    s_waitcnt lgkmcnt(0)
    s_mov_b32 s40, s4
    s_and_b32 s41, s5, 0xffff
    s_mov_b32 s42, 1835008
    s_mov_b32 s43, 0x20000
    s_mov_b32 s52, s36
    s_and_b32 s53, s37, 0xffff
    s_mov_b32 s54, 13545472
    s_mov_b32 s55, 0x20000
    s_cmp_ge_u32 s2, 224
    s_cbranch_scc1 K1_PREP
    s_and_b32 s71, s2, 7
    s_lshr_b32 s72, s2, 3
    s_lshr_b32 s73, s71, 1
    s_lshl_b32 s73, s73, 2
    s_and_b32 s74, s72, 3
    s_add_u32 s65, s73, s74
    s_and_b32 s73, s71, 1
    s_mul_i32 s73, s73, 7
    s_lshr_b32 s74, s72, 2
    s_add_u32 s66, s73, s74
    s_cmp_lt_u32 s64, 4
    s_cselect_b32 s44, s10, s12
    s_cselect_b32 s45, s11, s13
    s_cselect_b32 s48, s24, s26
    s_cselect_b32 s49, s25, s27
    s_and_b32 s45, s45, 0xffff
    s_mov_b32 s46, 401408
    s_mov_b32 s47, 0x20000
    s_and_b32 s49, s49, 0xffff
    s_mov_b32 s50, 1605632
    s_mov_b32 s51, 0x20000
    s_lshl_b32 s68, s64, 11
    s_lshl_b32 s69, s64, 10
    s_and_b32 s71, s64, 1
    s_lshl_b32 s71, s71, 1
    s_bfe_u32 s72, s64, 0x10001
    s_add_u32 s67, s71, s72
    s_movk_i32 s77, 896
    s_and_b32 s72, s64, 3
    v_lshrrev_b32 v28, 4, v1
    v_and_b32 v29, 15, v1
    v_lshlrev_b32 v30, 2, v28
    v_xor_b32 v29, v29, v30
    v_mul_u32_u24 v28, 3584, v28
    v_lshl_add_u32 v28, v29, 4, v28
    s_mul_i32 s71, s72, 28672
    s_lshl_b32 s73, s66, 8
    s_add_u32 s71, s71, s73
    v_add_u32 v5, s71, v28
    s_mov_b32 s71, 0
    s_add_u32 m0, s68, 73728
    s_nop 0
    buffer_load_dwordx4 v5, s[48:51], s71 offen lds
    s_mov_b32 s71, 14336
    s_add_u32 m0, s68, 74752
    s_nop 0
    buffer_load_dwordx4 v5, s[48:51], s71 offen lds
    v_lshrrev_b32 v28, 3, v1
    s_lshl_b32 s71, s64, 4
    s_add_u32 s71, s71, 0
    v_add_u32 v28, s71, v28
    v_and_b32 v29, 31, v28
    v_and_b32 v30, 3, v29
    v_lshrrev_b32 v31, 3, v29
    v_lshl_add_u32 v30, v31, 2, v30
    v_bfe_u32 v31, v29, 2, 1
    v_lshl_add_u32 v30, v31, 4, v30
    v_and_b32 v28, 96, v28
    v_add_u32 v28, v28, v30
    s_lshl_b32 s71, s65, 7
    v_add_u32 v28, s71, v28
    v_mul_lo_u32 v28, v28, s77
    v_bfe_u32 v29, v29, 1, 3
    v_and_b32 v30, 7, v1
    v_xor_b32 v29, v29, v30
    v_lshl_add_u32 v2, v29, 4, v28
    s_mov_b32 s71, 0
    s_add_u32 m0, s68, 0
    s_nop 0
    buffer_load_dwordx4 v2, s[40:43], s71 offen lds
    v_lshrrev_b32 v28, 3, v1
    s_lshl_b32 s71, s64, 4
    s_add_u32 s71, s71, 8
    v_add_u32 v28, s71, v28
    v_and_b32 v29, 31, v28
    v_and_b32 v30, 3, v29
    v_lshrrev_b32 v31, 3, v29
    v_lshl_add_u32 v30, v31, 2, v30
    v_bfe_u32 v31, v29, 2, 1
    v_lshl_add_u32 v30, v31, 4, v30
    v_and_b32 v28, 96, v28
    v_add_u32 v28, v28, v30
    s_lshl_b32 s71, s65, 7
    v_add_u32 v28, s71, v28
    v_mul_lo_u32 v28, v28, s77
    v_bfe_u32 v29, v29, 1, 3
    v_and_b32 v30, 7, v1
    v_xor_b32 v29, v29, v30
    v_lshl_add_u32 v3, v29, 4, v28
    s_mov_b32 s71, 0
    s_add_u32 m0, s68, 1024
    s_nop 0
    buffer_load_dwordx4 v3, s[40:43], s71 offen lds
    v_lshrrev_b32 v28, 3, v1
    s_and_b32 s72, s64, 3
    s_lshl_b32 s71, s72, 3
    v_add_u32 v28, s71, v28
    v_bfe_u32 v29, v28, 1, 3
    s_lshl_b32 s71, s66, 5
    v_add_u32 v28, s71, v28
    v_mul_lo_u32 v28, v28, s77
    v_xor_b32 v29, v29, v30
    v_lshl_add_u32 v4, v29, 4, v28
    s_mov_b32 s71, 0
    s_add_u32 m0, s69, 16384
    s_nop 0
    buffer_load_dwordx4 v4, s[44:47], s71 offen lds
    v_and_b32 v28, 31, v1
    s_lshl_b32 s71, s66, 5
    v_add_lshl_u32 v38, v28, s71, 1
    global_load_ushort v39, v38, s[6:7]
    global_load_ushort v40, v38, s[8:9]
    global_load_ushort v41, v38, s[18:19]
    s_mov_b32 s71, 114688
    s_add_u32 m0, s68, 90112
    s_nop 0
    buffer_load_dwordx4 v5, s[48:51], s71 offen lds
    s_mov_b32 s71, 129024
    s_add_u32 m0, s68, 91136
    s_nop 0
    buffer_load_dwordx4 v5, s[48:51], s71 offen lds
    s_mov_b32 s71, 128
    s_add_u32 m0, s68, 24576
    s_nop 0
    buffer_load_dwordx4 v2, s[40:43], s71 offen lds
    s_add_u32 m0, s68, 25600
    s_nop 0
    buffer_load_dwordx4 v3, s[40:43], s71 offen lds
    s_add_u32 m0, s69, 40960
    s_nop 0
    buffer_load_dwordx4 v4, s[44:47], s71 offen lds
    s_mov_b32 s71, 229376
    s_add_u32 m0, s68, 106496
    s_nop 0
    buffer_load_dwordx4 v5, s[48:51], s71 offen lds
    s_mov_b32 s71, 243712
    s_add_u32 m0, s68, 107520
    s_nop 0
    buffer_load_dwordx4 v5, s[48:51], s71 offen lds
    s_mov_b32 s71, 344064
    s_add_u32 m0, s68, 122880
    s_nop 0
    buffer_load_dwordx4 v5, s[48:51], s71 offen lds
    s_mov_b32 s71, 358400
    s_add_u32 m0, s68, 123904
    s_nop 0
    buffer_load_dwordx4 v5, s[48:51], s71 offen lds
    v_lshrrev_b32 v29, 5, v1
    v_bfe_u32 v30, v28, 1, 3
    s_lshl_b32 s71, s67, 12
    s_xor_b32 s72, s71, 4096
    v_add_u32 v31, 0, v29
    v_xor_b32 v31, v31, v30
    v_lshlrev_b32 v31, 4, v31
    v_lshl_add_u32 v31, v28, 7, v31
    v_add_u32 v6, s71, v31
    v_add_u32 v10, s72, v31
    v_add_u32 v14, 16384, v31
    v_add_u32 v31, 2, v29
    v_xor_b32 v31, v31, v30
    v_lshlrev_b32 v31, 4, v31
    v_lshl_add_u32 v31, v28, 7, v31
    v_add_u32 v7, s71, v31
    v_add_u32 v11, s72, v31
    v_add_u32 v15, 16384, v31
    v_add_u32 v31, 4, v29
    v_xor_b32 v31, v31, v30
    v_lshlrev_b32 v31, 4, v31
    v_lshl_add_u32 v31, v28, 7, v31
    v_add_u32 v8, s71, v31
    v_add_u32 v12, s72, v31
    v_add_u32 v16, 16384, v31
    v_add_u32 v31, 6, v29
    v_xor_b32 v31, v31, v30
    v_lshlrev_b32 v31, 4, v31
    v_lshl_add_u32 v31, v28, 7, v31
    v_add_u32 v9, s71, v31
    v_add_u32 v13, s72, v31
    v_add_u32 v17, 16384, v31
    v_bfe_u32 v30, v1, 2, 2
    v_lshl_add_u32 v31, v29, 3, v30
    v_lshlrev_b32 v31, 8, v31
    s_lshr_b32 s71, s64, 1
    v_xor_b32 v30, s71, v30
    v_lshl_add_u32 v31, v30, 6, v31
    v_bfe_u32 v30, v1, 4, 1
    v_lshl_add_u32 v31, v30, 5, v31
    v_and_b32 v30, 3, v1
    v_lshl_add_u32 v31, v30, 3, v31
    v_add_u32 v18, 73728, v31
    v_add_u32 v19, 122880, v31
    s_mov_b32 s56, s34
    s_and_b32 s57, s35, 0xffff
    s_mov_b32 s58, 256
    s_mov_b32 s59, 0x20000
    s_cmp_ge_u32 s66, 7
    s_cselect_b32 s94, 1, 0
    s_mul_i32 s95, s94, 7
    s_sub_u32 s95, s66, s95
    s_lshl_b32 s71, s65, 1
    s_add_u32 s94, s94, s71
    s_mul_i32 s71, s64, 14336
    s_mul_i32 s75, s64, 7168
    s_add_u32 s75, s75, 114688
    s_mul_i32 s77, s95, 344064
    s_add_u32 s77, s77, 11010048
    s_add_u32 s82, s77, s71
    s_add_u32 s83, s82, 172032
    s_add_u32 s84, s77, s75
    s_add_u32 s85, s84, 172032
    s_mul_i32 s77, s94, 344064
    s_add_u32 s86, s77, s71
    s_add_u32 s87, s86, 172032
    s_add_u32 s88, s77, s75
    s_add_u32 s89, s88, 172032
    s_mul_i32 s4, s95, 2048
    s_mul_i32 s18, s95, 1024
    s_add_u32 s5, s4, 1024
    s_cmp_eq_u32 s5, 14336
    s_cselect_b32 s5, 0, s5
    s_add_u32 s6, s5, 1024
    s_cmp_eq_u32 s6, 14336
    s_cselect_b32 s6, 0, s6
    s_add_u32 s7, s6, 1024
    s_cmp_eq_u32 s7, 14336
    s_cselect_b32 s7, 0, s7
    s_add_u32 s8, s7, 1024
    s_cmp_eq_u32 s8, 14336
    s_cselect_b32 s8, 0, s8
    s_add_u32 s9, s8, 1024
    s_cmp_eq_u32 s9, 14336
    s_cselect_b32 s9, 0, s9
    s_add_u32 s10, s9, 1024
    s_cmp_eq_u32 s10, 14336
    s_cselect_b32 s10, 0, s10
    s_add_u32 s11, s10, 1024
    s_cmp_eq_u32 s11, 14336
    s_cselect_b32 s11, 0, s11
    s_add_u32 s12, s11, 1024
    s_cmp_eq_u32 s12, 14336
    s_cselect_b32 s12, 0, s12
    s_add_u32 s13, s12, 1024
    s_cmp_eq_u32 s13, 14336
    s_cselect_b32 s13, 0, s13
    s_add_u32 s14, s13, 1024
    s_cmp_eq_u32 s14, 14336
    s_cselect_b32 s14, 0, s14
    s_add_u32 s15, s14, 1024
    s_cmp_eq_u32 s15, 14336
    s_cselect_b32 s15, 0, s15
    s_add_u32 s16, s15, 1024
    s_cmp_eq_u32 s16, 14336
    s_cselect_b32 s16, 0, s16
    s_add_u32 s17, s16, 1024
    s_cmp_eq_u32 s17, 14336
    s_cselect_b32 s17, 0, s17
    s_add_u32 s19, s18, 1024
    s_cmp_eq_u32 s19, 7168
    s_cselect_b32 s19, 0, s19
    s_add_u32 s22, s19, 1024
    s_cmp_eq_u32 s22, 7168
    s_cselect_b32 s22, 0, s22
    s_add_u32 s23, s22, 1024
    s_cmp_eq_u32 s23, 7168
    s_cselect_b32 s23, 0, s23
    s_add_u32 s24, s23, 1024
    s_cmp_eq_u32 s24, 7168
    s_cselect_b32 s24, 0, s24
    s_add_u32 s25, s24, 1024
    s_cmp_eq_u32 s25, 7168
    s_cselect_b32 s25, 0, s25
    s_add_u32 s26, s25, 1024
    s_cmp_eq_u32 s26, 7168
    s_cselect_b32 s26, 0, s26
    s_lshl_b32 s27, s64, 14
    s_sub_u32 s28, s27, 65536
    s_and_b32 s71, s2, 7
    s_lshl_b32 s71, s71, 7
    s_add_u32 s71, s71, 13541376
    s_lshl_b32 s72, s2, 7
    s_and_b32 s72, s72, 128
    s_cmp_eq_u32 s64, 4
    s_cselect_b32 s71, s71, 0x7f000000
    s_cselect_b32 s72, s72, 0x7f000000
    v_and_b32 v45, 31, v1
    v_lshl_add_u32 v45, v45, 2, s71
    v_mov_b32 v44, s72
    v_lshlrev_b32 v46, 4, v1
    s_cmp_ge_u32 s64, 4
    s_cbranch_scc1 K1_PLAIN
    s_waitcnt vmcnt(9)
    v_lshlrev_b32 v39, 16, v39
    v_lshlrev_b32 v40, 16, v40
    v_lshlrev_b32 v41, 16, v41
    v_mul_f32 v41, 0x3fb8aa3b, v41
    v_exp_f32 v41, v41
    s_nop 0
    v_cvt_pk_bf16_f32 v41, v41, v41
    v_lshlrev_b32 v41, 16, v41
    v_mul_f32 v28, v41, v39
    v_mul_f32 v29, v41, v40
    v_mul_f32 v28, 0x3fb8aa3b, v28
    v_mul_f32 v29, 0x3e22f983, v29
    v_rndne_f32 v30, v29
    v_sub_f32 v29, v29, v30
    v_exp_f32 v28, v28
    v_cos_f32 v30, v29
    v_sin_f32 v31, v29
    s_nop 0
    v_mul_f32 v20, v28, v30
    v_mul_f32 v21, v28, v31
    v_add_f32 v28, -1.0, v20
    v_mul_f32 v29, v39, v39
    v_fma_f32 v29, v40, v40, v29
    v_rcp_f32 v29, v29
    v_mul_f32 v22, v28, v39
    v_mul_f32 v23, v21, v39
    v_fma_f32 v22, v21, v40, v22
    v_fma_f32 v23, -v28, v40, v23
    v_add_f32 v29, v29, v29
    v_mul_f32 v22, v22, v29
    v_mul_f32 v23, v23, v29
    v_mul_f32 v28, v20, v20
    v_mul_f32 v29, v20, v21
    v_fma_f32 v28, -v21, v21, v28
    v_fma_f32 v29, v21, v20, v29
    v_mul_f32 v30, v28, v28
    v_mul_f32 v31, v28, v29
    v_fma_f32 v30, -v29, v29, v30
    v_fma_f32 v31, v29, v28, v31
    v_mul_f32 v28, v30, v30
    v_mul_f32 v29, v30, v31
    v_fma_f32 v28, -v31, v31, v28
    v_fma_f32 v29, v31, v30, v29
    v_mul_f32 v24, v28, v28
    v_mul_f32 v25, v28, v29
    v_fma_f32 v24, -v29, v29, v24
    v_fma_f32 v25, v29, v28, v25
    v_mul_f32 v28, v24, v24
    v_mul_f32 v29, v24, v25
    v_fma_f32 v28, -v25, v25, v28
    v_fma_f32 v29, v25, v24, v29
    v_mul_f32 v30, v28, v28
    v_mul_f32 v31, v28, v29
    v_fma_f32 v30, -v29, v29, v30
    v_fma_f32 v31, v29, v28, v31
    v_mul_f32 v26, v30, v30
    v_mul_f32 v27, v30, v31
    v_fma_f32 v26, -v31, v31, v26
    v_fma_f32 v27, v31, v30, v27
    s_waitcnt vmcnt(9)
    s_barrier
    ds_read_b64_tr_b16 v[56:57], v18 offset:0
    ds_read_b64_tr_b16 v[58:59], v18 offset:1024
    ds_read_b128 v[48:51], v6 offset:0
    ds_read_b128 v[52:55], v10 offset:0
    ds_read_b64_tr_b16 v[60:61], v18 offset:8192
    ds_read_b64_tr_b16 v[62:63], v18 offset:9216
    ds_read_b128 v[64:67], v14 offset:0
    ds_read_b128 v[68:71], v14 offset:4096
    s_waitcnt vmcnt(7) lgkmcnt(0)
    s_barrier
    v_mfma_f32_32x32x16_bf16 v[96:111], v[56:59], v[48:51], 0
    ds_read_b64_tr_b16 v[80:81], v18 offset:4096
    ds_read_b64_tr_b16 v[82:83], v18 offset:5120
    v_mfma_f32_32x32x16_bf16 v[112:127], v[56:59], v[52:55], 0
    ds_read_b128 v[72:75], v7 offset:0
    ds_read_b128 v[76:79], v11 offset:0
    v_mfma_f32_32x32x16_bf16 v[128:143], v[60:63], v[48:51], 0
    ds_read_b64_tr_b16 v[84:85], v18 offset:12288
    ds_read_b64_tr_b16 v[86:87], v18 offset:13312
    v_mfma_f32_32x32x16_bf16 v[144:159], v[60:63], v[52:55], 0
    ds_read_b128 v[88:91], v15 offset:0
    ds_read_b128 v[92:95], v15 offset:4096
    s_mov_b32 s71, 256
    s_add_u32 m0, s68, 49152
    s_nop 0
    buffer_load_dwordx4 v2, s[40:43], s71 offen lds
    s_add_u32 m0, s68, 50176
    s_nop 0
    buffer_load_dwordx4 v3, s[40:43], s71 offen lds
    s_add_u32 m0, s69, 65536
    s_nop 0
    buffer_load_dwordx4 v4, s[44:47], s71 offen lds
    s_mov_b32 s71, 458752
    s_add_u32 m0, s68, 139264
    s_nop 0
    buffer_load_dwordx4 v5, s[48:51], s71 offen lds
    s_mov_b32 s71, 473088
    s_add_u32 m0, s68, 140288
    s_nop 0
    buffer_load_dwordx4 v5, s[48:51], s71 offen lds
    v_mfma_f32_32x32x16_bf16 v[160:175], v[48:51], v[64:67], 0
    v_mfma_f32_32x32x16_bf16 v[176:191], v[48:51], v[68:71], 0
    s_waitcnt lgkmcnt(0)
    v_mfma_f32_32x32x16_bf16 v[96:111], v[80:83], v[72:75], v[96:111]
    ds_read_b64_tr_b16 v[56:57], v18 offset:16384
    ds_read_b64_tr_b16 v[58:59], v18 offset:17408
    v_mfma_f32_32x32x16_bf16 v[112:127], v[80:83], v[76:79], v[112:127]
    ds_read_b128 v[48:51], v8 offset:0
    ds_read_b128 v[52:55], v12 offset:0
    v_mfma_f32_32x32x16_bf16 v[128:143], v[84:87], v[72:75], v[128:143]
    ds_read_b64_tr_b16 v[60:61], v18 offset:24576
    ds_read_b64_tr_b16 v[62:63], v18 offset:25600
    v_mfma_f32_32x32x16_bf16 v[144:159], v[84:87], v[76:79], v[144:159]
    ds_read_b128 v[64:67], v16 offset:0
    ds_read_b128 v[68:71], v16 offset:4096
    v_mfma_f32_32x32x16_bf16 v[160:175], v[72:75], v[88:91], v[160:175]
    v_mfma_f32_32x32x16_bf16 v[176:191], v[72:75], v[92:95], v[176:191]
    s_waitcnt vmcnt(7) lgkmcnt(0)
    s_barrier
    v_mfma_f32_32x32x16_bf16 v[96:111], v[56:59], v[48:51], v[96:111]
    ds_read_b64_tr_b16 v[80:81], v18 offset:20480
    ds_read_b64_tr_b16 v[82:83], v18 offset:21504
    v_mfma_f32_32x32x16_bf16 v[112:127], v[56:59], v[52:55], v[112:127]
    ds_read_b128 v[72:75], v9 offset:0
    ds_read_b128 v[76:79], v13 offset:0
    v_mfma_f32_32x32x16_bf16 v[128:143], v[60:63], v[48:51], v[128:143]
    ds_read_b64_tr_b16 v[84:85], v18 offset:28672
    ds_read_b64_tr_b16 v[86:87], v18 offset:29696
    v_mfma_f32_32x32x16_bf16 v[144:159], v[60:63], v[52:55], v[144:159]
    ds_read_b128 v[88:91], v17 offset:0
    ds_read_b128 v[92:95], v17 offset:4096
    s_mov_b32 s71, 573440
    s_add_u32 m0, s68, 73728
    s_nop 0
    buffer_load_dwordx4 v5, s[48:51], s71 offen lds
    s_mov_b32 s71, 587776
    s_add_u32 m0, s68, 74752
    s_nop 0
    buffer_load_dwordx4 v5, s[48:51], s71 offen lds
    v_mfma_f32_32x32x16_bf16 v[160:175], v[48:51], v[64:67], v[160:175]
    v_mfma_f32_32x32x16_bf16 v[176:191], v[48:51], v[68:71], v[176:191]
    s_waitcnt lgkmcnt(0)
    v_mfma_f32_32x32x16_bf16 v[96:111], v[80:83], v[72:75], v[96:111]
    ds_read_b64_tr_b16 v[56:57], v18 offset:32768
    ds_read_b64_tr_b16 v[58:59], v18 offset:33792
    v_mfma_f32_32x32x16_bf16 v[112:127], v[80:83], v[76:79], v[112:127]
    ds_read_b128 v[48:51], v6 offset:24576
    ds_read_b128 v[52:55], v10 offset:24576
    v_mfma_f32_32x32x16_bf16 v[128:143], v[84:87], v[72:75], v[128:143]
    ds_read_b64_tr_b16 v[60:61], v18 offset:40960
    ds_read_b64_tr_b16 v[62:63], v18 offset:41984
    v_mfma_f32_32x32x16_bf16 v[144:159], v[84:87], v[76:79], v[144:159]
    ds_read_b128 v[64:67], v14 offset:24576
    ds_read_b128 v[68:71], v14 offset:28672
    v_mfma_f32_32x32x16_bf16 v[160:175], v[72:75], v[88:91], v[160:175]
    v_mfma_f32_32x32x16_bf16 v[176:191], v[72:75], v[92:95], v[176:191]
    s_waitcnt vmcnt(7) lgkmcnt(0)
    s_barrier
    v_mfma_f32_32x32x16_bf16 v[96:111], v[56:59], v[48:51], v[96:111]
    ds_read_b64_tr_b16 v[80:81], v18 offset:36864
    ds_read_b64_tr_b16 v[82:83], v18 offset:37888
    v_mfma_f32_32x32x16_bf16 v[112:127], v[56:59], v[52:55], v[112:127]
    ds_read_b128 v[72:75], v7 offset:24576
    ds_read_b128 v[76:79], v11 offset:24576
    v_mfma_f32_32x32x16_bf16 v[128:143], v[60:63], v[48:51], v[128:143]
    ds_read_b64_tr_b16 v[84:85], v18 offset:45056
    ds_read_b64_tr_b16 v[86:87], v18 offset:46080
    v_mfma_f32_32x32x16_bf16 v[144:159], v[60:63], v[52:55], v[144:159]
    ds_read_b128 v[88:91], v15 offset:24576
    ds_read_b128 v[92:95], v15 offset:28672
    s_mov_b32 s71, 384
    s_add_u32 m0, s68, 0
    s_nop 0
    buffer_load_dwordx4 v2, s[40:43], s71 offen lds
    s_add_u32 m0, s68, 1024
    s_nop 0
    buffer_load_dwordx4 v3, s[40:43], s71 offen lds
    s_add_u32 m0, s69, 16384
    s_nop 0
    buffer_load_dwordx4 v4, s[44:47], s71 offen lds
    s_mov_b32 s71, 688128
    s_add_u32 m0, s68, 90112
    s_nop 0
    buffer_load_dwordx4 v5, s[48:51], s71 offen lds
    s_mov_b32 s71, 702464
    s_add_u32 m0, s68, 91136
    s_nop 0
    buffer_load_dwordx4 v5, s[48:51], s71 offen lds
    v_mfma_f32_32x32x16_bf16 v[160:175], v[48:51], v[64:67], v[160:175]
    v_mfma_f32_32x32x16_bf16 v[176:191], v[48:51], v[68:71], v[176:191]
    s_waitcnt lgkmcnt(0)
    v_mfma_f32_32x32x16_bf16 v[96:111], v[80:83], v[72:75], v[96:111]
    ds_read_b64_tr_b16 v[56:57], v19 offset:0
    ds_read_b64_tr_b16 v[58:59], v19 offset:1024
    v_mfma_f32_32x32x16_bf16 v[112:127], v[80:83], v[76:79], v[112:127]
    ds_read_b128 v[48:51], v8 offset:24576
    ds_read_b128 v[52:55], v12 offset:24576
    v_mfma_f32_32x32x16_bf16 v[128:143], v[84:87], v[72:75], v[128:143]
    ds_read_b64_tr_b16 v[60:61], v19 offset:8192
    ds_read_b64_tr_b16 v[62:63], v19 offset:9216
    v_mfma_f32_32x32x16_bf16 v[144:159], v[84:87], v[76:79], v[144:159]
    ds_read_b128 v[64:67], v16 offset:24576
    ds_read_b128 v[68:71], v16 offset:28672
    v_mfma_f32_32x32x16_bf16 v[160:175], v[72:75], v[88:91], v[160:175]
    v_mfma_f32_32x32x16_bf16 v[176:191], v[72:75], v[92:95], v[176:191]
    s_waitcnt vmcnt(7) lgkmcnt(0)
    s_barrier
    v_mfma_f32_32x32x16_bf16 v[96:111], v[56:59], v[48:51], v[96:111]
    ds_read_b64_tr_b16 v[80:81], v19 offset:4096
    ds_read_b64_tr_b16 v[82:83], v19 offset:5120
    v_mfma_f32_32x32x16_bf16 v[112:127], v[56:59], v[52:55], v[112:127]
    ds_read_b128 v[72:75], v9 offset:24576
    ds_read_b128 v[76:79], v13 offset:24576
    v_mfma_f32_32x32x16_bf16 v[128:143], v[60:63], v[48:51], v[128:143]
    ds_read_b64_tr_b16 v[84:85], v19 offset:12288
    ds_read_b64_tr_b16 v[86:87], v19 offset:13312
    v_mfma_f32_32x32x16_bf16 v[144:159], v[60:63], v[52:55], v[144:159]
    ds_read_b128 v[88:91], v17 offset:24576
    ds_read_b128 v[92:95], v17 offset:28672
    s_mov_b32 s71, 802816
    s_add_u32 m0, s68, 106496
    s_nop 0
    buffer_load_dwordx4 v5, s[48:51], s71 offen lds
    s_mov_b32 s71, 817152
    s_add_u32 m0, s68, 107520
    s_nop 0
    buffer_load_dwordx4 v5, s[48:51], s71 offen lds
    v_mfma_f32_32x32x16_bf16 v[160:175], v[48:51], v[64:67], v[160:175]
    v_mfma_f32_32x32x16_bf16 v[176:191], v[48:51], v[68:71], v[176:191]
    s_waitcnt lgkmcnt(0)
    v_mfma_f32_32x32x16_bf16 v[96:111], v[80:83], v[72:75], v[96:111]
    ds_read_b64_tr_b16 v[56:57], v19 offset:16384
    ds_read_b64_tr_b16 v[58:59], v19 offset:17408
    v_mfma_f32_32x32x16_bf16 v[112:127], v[80:83], v[76:79], v[112:127]
    ds_read_b128 v[48:51], v6 offset:49152
    ds_read_b128 v[52:55], v10 offset:49152
    v_mfma_f32_32x32x16_bf16 v[128:143], v[84:87], v[72:75], v[128:143]
    ds_read_b64_tr_b16 v[60:61], v19 offset:24576
    ds_read_b64_tr_b16 v[62:63], v19 offset:25600
    v_mfma_f32_32x32x16_bf16 v[144:159], v[84:87], v[76:79], v[144:159]
    ds_read_b128 v[64:67], v14 offset:49152
    ds_read_b128 v[68:71], v14 offset:53248
    v_mfma_f32_32x32x16_bf16 v[160:175], v[72:75], v[88:91], v[160:175]
    v_mfma_f32_32x32x16_bf16 v[176:191], v[72:75], v[92:95], v[176:191]
    s_waitcnt vmcnt(7) lgkmcnt(0)
    s_barrier
    v_mfma_f32_32x32x16_bf16 v[96:111], v[56:59], v[48:51], v[96:111]
    ds_read_b64_tr_b16 v[80:81], v19 offset:20480
    ds_read_b64_tr_b16 v[82:83], v19 offset:21504
    v_mfma_f32_32x32x16_bf16 v[112:127], v[56:59], v[52:55], v[112:127]
    ds_read_b128 v[72:75], v7 offset:49152
    ds_read_b128 v[76:79], v11 offset:49152
    v_mfma_f32_32x32x16_bf16 v[128:143], v[60:63], v[48:51], v[128:143]
    ds_read_b64_tr_b16 v[84:85], v19 offset:28672
    ds_read_b64_tr_b16 v[86:87], v19 offset:29696
    v_mfma_f32_32x32x16_bf16 v[144:159], v[60:63], v[52:55], v[144:159]
    ds_read_b128 v[88:91], v15 offset:49152
    ds_read_b128 v[92:95], v15 offset:53248
    s_mov_b32 s71, 512
    s_add_u32 m0, s68, 24576
    s_nop 0
    buffer_load_dwordx4 v2, s[40:43], s71 offen lds
    s_add_u32 m0, s68, 25600
    s_nop 0
    buffer_load_dwordx4 v3, s[40:43], s71 offen lds
    s_add_u32 m0, s69, 40960
    s_nop 0
    buffer_load_dwordx4 v4, s[44:47], s71 offen lds
    s_mov_b32 s71, 917504
    s_add_u32 m0, s68, 122880
    s_nop 0
    buffer_load_dwordx4 v5, s[48:51], s71 offen lds
    s_mov_b32 s71, 931840
    s_add_u32 m0, s68, 123904
    s_nop 0
    buffer_load_dwordx4 v5, s[48:51], s71 offen lds
    v_mfma_f32_32x32x16_bf16 v[160:175], v[48:51], v[64:67], v[160:175]
    v_mfma_f32_32x32x16_bf16 v[176:191], v[48:51], v[68:71], v[176:191]
    s_waitcnt lgkmcnt(0)
    v_mfma_f32_32x32x16_bf16 v[96:111], v[80:83], v[72:75], v[96:111]
    ds_read_b64_tr_b16 v[56:57], v18 offset:0
    ds_read_b64_tr_b16 v[58:59], v18 offset:1024
    v_mfma_f32_32x32x16_bf16 v[112:127], v[80:83], v[76:79], v[112:127]
    ds_read_b128 v[48:51], v8 offset:49152
    ds_read_b128 v[52:55], v12 offset:49152
    v_mfma_f32_32x32x16_bf16 v[128:143], v[84:87], v[72:75], v[128:143]
    ds_read_b64_tr_b16 v[60:61], v18 offset:8192
    ds_read_b64_tr_b16 v[62:63], v18 offset:9216
    v_mfma_f32_32x32x16_bf16 v[144:159], v[84:87], v[76:79], v[144:159]
    ds_read_b128 v[64:67], v16 offset:49152
    ds_read_b128 v[68:71], v16 offset:53248
    v_mfma_f32_32x32x16_bf16 v[160:175], v[72:75], v[88:91], v[160:175]
    v_mfma_f32_32x32x16_bf16 v[176:191], v[72:75], v[92:95], v[176:191]
    s_waitcnt vmcnt(7) lgkmcnt(0)
    s_barrier
    v_mfma_f32_32x32x16_bf16 v[96:111], v[56:59], v[48:51], v[96:111]
    ds_read_b64_tr_b16 v[80:81], v18 offset:4096
    ds_read_b64_tr_b16 v[82:83], v18 offset:5120
    v_mfma_f32_32x32x16_bf16 v[112:127], v[56:59], v[52:55], v[112:127]
    ds_read_b128 v[72:75], v9 offset:49152
    ds_read_b128 v[76:79], v13 offset:49152
    v_mfma_f32_32x32x16_bf16 v[128:143], v[60:63], v[48:51], v[128:143]
    ds_read_b64_tr_b16 v[84:85], v18 offset:12288
    ds_read_b64_tr_b16 v[86:87], v18 offset:13312
    v_mfma_f32_32x32x16_bf16 v[144:159], v[60:63], v[52:55], v[144:159]
    ds_read_b128 v[88:91], v17 offset:49152
    ds_read_b128 v[92:95], v17 offset:53248
    s_mov_b32 s71, 1032192
    s_add_u32 m0, s68, 139264
    s_nop 0
    buffer_load_dwordx4 v5, s[48:51], s71 offen lds
    s_mov_b32 s71, 1046528
    s_add_u32 m0, s68, 140288
    s_nop 0
    buffer_load_dwordx4 v5, s[48:51], s71 offen lds
    v_mfma_f32_32x32x16_bf16 v[160:175], v[48:51], v[64:67], v[160:175]
    v_mfma_f32_32x32x16_bf16 v[176:191], v[48:51], v[68:71], v[176:191]
    s_waitcnt lgkmcnt(0)
    v_mfma_f32_32x32x16_bf16 v[96:111], v[80:83], v[72:75], v[96:111]
    ds_read_b64_tr_b16 v[56:57], v18 offset:16384
    ds_read_b64_tr_b16 v[58:59], v18 offset:17408
    v_mfma_f32_32x32x16_bf16 v[112:127], v[80:83], v[76:79], v[112:127]
    ds_read_b128 v[48:51], v6 offset:0
    ds_read_b128 v[52:55], v10 offset:0
    v_mfma_f32_32x32x16_bf16 v[128:143], v[84:87], v[72:75], v[128:143]
    ds_read_b64_tr_b16 v[60:61], v18 offset:24576
    ds_read_b64_tr_b16 v[62:63], v18 offset:25600
    v_mfma_f32_32x32x16_bf16 v[144:159], v[84:87], v[76:79], v[144:159]
    ds_read_b128 v[64:67], v14 offset:0
    ds_read_b128 v[68:71], v14 offset:4096
    v_mfma_f32_32x32x16_bf16 v[160:175], v[72:75], v[88:91], v[160:175]
    v_mfma_f32_32x32x16_bf16 v[176:191], v[72:75], v[92:95], v[176:191]
    s_waitcnt vmcnt(7) lgkmcnt(0)
    s_barrier
    v_mfma_f32_32x32x16_bf16 v[96:111], v[56:59], v[48:51], v[96:111]
    ds_read_b64_tr_b16 v[80:81], v18 offset:20480
    ds_read_b64_tr_b16 v[82:83], v18 offset:21504
    v_mfma_f32_32x32x16_bf16 v[112:127], v[56:59], v[52:55], v[112:127]
    ds_read_b128 v[72:75], v7 offset:0
    ds_read_b128 v[76:79], v11 offset:0
    v_mfma_f32_32x32x16_bf16 v[128:143], v[60:63], v[48:51], v[128:143]
    ds_read_b64_tr_b16 v[84:85], v18 offset:28672
    ds_read_b64_tr_b16 v[86:87], v18 offset:29696
    v_mfma_f32_32x32x16_bf16 v[144:159], v[60:63], v[52:55], v[144:159]
    ds_read_b128 v[88:91], v15 offset:0
    ds_read_b128 v[92:95], v15 offset:4096
    s_mov_b32 s71, 640
    s_add_u32 m0, s68, 49152
    s_nop 0
    buffer_load_dwordx4 v2, s[40:43], s71 offen lds
    s_add_u32 m0, s68, 50176
    s_nop 0
    buffer_load_dwordx4 v3, s[40:43], s71 offen lds
    s_add_u32 m0, s69, 65536
    s_nop 0
    buffer_load_dwordx4 v4, s[44:47], s71 offen lds
    s_mov_b32 s71, 1146880
    s_add_u32 m0, s68, 73728
    s_nop 0
    buffer_load_dwordx4 v5, s[48:51], s71 offen lds
    s_mov_b32 s71, 1161216
    s_add_u32 m0, s68, 74752
    s_nop 0
    buffer_load_dwordx4 v5, s[48:51], s71 offen lds
    v_mfma_f32_32x32x16_bf16 v[160:175], v[48:51], v[64:67], v[160:175]
    v_mfma_f32_32x32x16_bf16 v[176:191], v[48:51], v[68:71], v[176:191]
    s_waitcnt lgkmcnt(0)
    v_mfma_f32_32x32x16_bf16 v[96:111], v[80:83], v[72:75], v[96:111]
    ds_read_b64_tr_b16 v[56:57], v18 offset:32768
    ds_read_b64_tr_b16 v[58:59], v18 offset:33792
    v_mfma_f32_32x32x16_bf16 v[112:127], v[80:83], v[76:79], v[112:127]
    ds_read_b128 v[48:51], v8 offset:0
    ds_read_b128 v[52:55], v12 offset:0
    v_mfma_f32_32x32x16_bf16 v[128:143], v[84:87], v[72:75], v[128:143]
    ds_read_b64_tr_b16 v[60:61], v18 offset:40960
    ds_read_b64_tr_b16 v[62:63], v18 offset:41984
    v_mfma_f32_32x32x16_bf16 v[144:159], v[84:87], v[76:79], v[144:159]
    ds_read_b128 v[64:67], v16 offset:0
    ds_read_b128 v[68:71], v16 offset:4096
    v_mfma_f32_32x32x16_bf16 v[160:175], v[72:75], v[88:91], v[160:175]
    v_mfma_f32_32x32x16_bf16 v[176:191], v[72:75], v[92:95], v[176:191]
    s_waitcnt vmcnt(7) lgkmcnt(0)
    s_barrier
    v_mfma_f32_32x32x16_bf16 v[96:111], v[56:59], v[48:51], v[96:111]
    ds_read_b64_tr_b16 v[80:81], v18 offset:36864
    ds_read_b64_tr_b16 v[82:83], v18 offset:37888
    v_mfma_f32_32x32x16_bf16 v[112:127], v[56:59], v[52:55], v[112:127]
    ds_read_b128 v[72:75], v9 offset:0
    ds_read_b128 v[76:79], v13 offset:0
    v_mfma_f32_32x32x16_bf16 v[128:143], v[60:63], v[48:51], v[128:143]
    ds_read_b64_tr_b16 v[84:85], v18 offset:45056
    ds_read_b64_tr_b16 v[86:87], v18 offset:46080
    v_mfma_f32_32x32x16_bf16 v[144:159], v[60:63], v[52:55], v[144:159]
    ds_read_b128 v[88:91], v17 offset:0
    ds_read_b128 v[92:95], v17 offset:4096
    s_mov_b32 s71, 1261568
    s_add_u32 m0, s68, 90112
    s_nop 0
    buffer_load_dwordx4 v5, s[48:51], s71 offen lds
    s_mov_b32 s71, 1275904
    s_add_u32 m0, s68, 91136
    s_nop 0
    buffer_load_dwordx4 v5, s[48:51], s71 offen lds
    v_mfma_f32_32x32x16_bf16 v[160:175], v[48:51], v[64:67], v[160:175]
    v_mfma_f32_32x32x16_bf16 v[176:191], v[48:51], v[68:71], v[176:191]
    s_waitcnt lgkmcnt(0)
    v_mfma_f32_32x32x16_bf16 v[96:111], v[80:83], v[72:75], v[96:111]
    ds_read_b64_tr_b16 v[56:57], v19 offset:0
    ds_read_b64_tr_b16 v[58:59], v19 offset:1024
    v_mfma_f32_32x32x16_bf16 v[112:127], v[80:83], v[76:79], v[112:127]
    ds_read_b128 v[48:51], v6 offset:24576
    ds_read_b128 v[52:55], v10 offset:24576
    v_mfma_f32_32x32x16_bf16 v[128:143], v[84:87], v[72:75], v[128:143]
    ds_read_b64_tr_b16 v[60:61], v19 offset:8192
    ds_read_b64_tr_b16 v[62:63], v19 offset:9216
    v_mfma_f32_32x32x16_bf16 v[144:159], v[84:87], v[76:79], v[144:159]
    ds_read_b128 v[64:67], v14 offset:24576
    ds_read_b128 v[68:71], v14 offset:28672
    v_mfma_f32_32x32x16_bf16 v[160:175], v[72:75], v[88:91], v[160:175]
    v_mfma_f32_32x32x16_bf16 v[176:191], v[72:75], v[92:95], v[176:191]
    s_waitcnt vmcnt(7) lgkmcnt(0)
    s_barrier
    v_mfma_f32_32x32x16_bf16 v[96:111], v[56:59], v[48:51], v[96:111]
    ds_read_b64_tr_b16 v[80:81], v19 offset:4096
    ds_read_b64_tr_b16 v[82:83], v19 offset:5120
    v_mfma_f32_32x32x16_bf16 v[112:127], v[56:59], v[52:55], v[112:127]
    ds_read_b128 v[72:75], v7 offset:24576
    ds_read_b128 v[76:79], v11 offset:24576
    v_mfma_f32_32x32x16_bf16 v[128:143], v[60:63], v[48:51], v[128:143]
    ds_read_b64_tr_b16 v[84:85], v19 offset:12288
    ds_read_b64_tr_b16 v[86:87], v19 offset:13312
    v_mfma_f32_32x32x16_bf16 v[144:159], v[60:63], v[52:55], v[144:159]
    ds_read_b128 v[88:91], v15 offset:24576
    ds_read_b128 v[92:95], v15 offset:28672
    s_mov_b32 s71, 768
    s_add_u32 m0, s68, 0
    s_nop 0
    buffer_load_dwordx4 v2, s[40:43], s71 offen lds
    s_add_u32 m0, s68, 1024
    s_nop 0
    buffer_load_dwordx4 v3, s[40:43], s71 offen lds
    s_add_u32 m0, s69, 16384
    s_nop 0
    buffer_load_dwordx4 v4, s[44:47], s71 offen lds
    s_mov_b32 s71, 1376256
    s_add_u32 m0, s68, 106496
    s_nop 0
    buffer_load_dwordx4 v5, s[48:51], s71 offen lds
    s_mov_b32 s71, 1390592
    s_add_u32 m0, s68, 107520
    s_nop 0
    buffer_load_dwordx4 v5, s[48:51], s71 offen lds
    v_mfma_f32_32x32x16_bf16 v[160:175], v[48:51], v[64:67], v[160:175]
    v_mfma_f32_32x32x16_bf16 v[176:191], v[48:51], v[68:71], v[176:191]
    s_waitcnt lgkmcnt(0)
    v_mfma_f32_32x32x16_bf16 v[96:111], v[80:83], v[72:75], v[96:111]
    ds_read_b64_tr_b16 v[56:57], v19 offset:16384
    ds_read_b64_tr_b16 v[58:59], v19 offset:17408
    v_mfma_f32_32x32x16_bf16 v[112:127], v[80:83], v[76:79], v[112:127]
    ds_read_b128 v[48:51], v8 offset:24576
    ds_read_b128 v[52:55], v12 offset:24576
    v_mfma_f32_32x32x16_bf16 v[128:143], v[84:87], v[72:75], v[128:143]
    ds_read_b64_tr_b16 v[60:61], v19 offset:24576
    ds_read_b64_tr_b16 v[62:63], v19 offset:25600
    v_mfma_f32_32x32x16_bf16 v[144:159], v[84:87], v[76:79], v[144:159]
    ds_read_b128 v[64:67], v16 offset:24576
    ds_read_b128 v[68:71], v16 offset:28672
    v_mfma_f32_32x32x16_bf16 v[160:175], v[72:75], v[88:91], v[160:175]
    v_mfma_f32_32x32x16_bf16 v[176:191], v[72:75], v[92:95], v[176:191]
    s_waitcnt vmcnt(7) lgkmcnt(0)
    s_barrier
    v_mfma_f32_32x32x16_bf16 v[96:111], v[56:59], v[48:51], v[96:111]
    ds_read_b64_tr_b16 v[80:81], v19 offset:20480
    ds_read_b64_tr_b16 v[82:83], v19 offset:21504
    v_mfma_f32_32x32x16_bf16 v[112:127], v[56:59], v[52:55], v[112:127]
    ds_read_b128 v[72:75], v9 offset:24576
    ds_read_b128 v[76:79], v13 offset:24576
    v_mfma_f32_32x32x16_bf16 v[128:143], v[60:63], v[48:51], v[128:143]
    ds_read_b64_tr_b16 v[84:85], v19 offset:28672
    ds_read_b64_tr_b16 v[86:87], v19 offset:29696
    v_mfma_f32_32x32x16_bf16 v[144:159], v[60:63], v[52:55], v[144:159]
    ds_read_b128 v[88:91], v17 offset:24576
    ds_read_b128 v[92:95], v17 offset:28672
    s_mov_b32 s71, 1490944
    s_add_u32 m0, s68, 122880
    s_nop 0
    buffer_load_dwordx4 v5, s[48:51], s71 offen lds
    s_mov_b32 s71, 1505280
    s_add_u32 m0, s68, 123904
    s_nop 0
    buffer_load_dwordx4 v5, s[48:51], s71 offen lds
    v_mfma_f32_32x32x16_bf16 v[160:175], v[48:51], v[64:67], v[160:175]
    v_mfma_f32_32x32x16_bf16 v[176:191], v[48:51], v[68:71], v[176:191]
    s_waitcnt lgkmcnt(0)
    v_mfma_f32_32x32x16_bf16 v[96:111], v[80:83], v[72:75], v[96:111]
    ds_read_b64_tr_b16 v[56:57], v18 offset:0
    ds_read_b64_tr_b16 v[58:59], v18 offset:1024
    v_mfma_f32_32x32x16_bf16 v[112:127], v[80:83], v[76:79], v[112:127]
    ds_read_b128 v[48:51], v6 offset:49152
    ds_read_b128 v[52:55], v10 offset:49152
    v_mfma_f32_32x32x16_bf16 v[128:143], v[84:87], v[72:75], v[128:143]
    ds_read_b64_tr_b16 v[60:61], v18 offset:8192
    ds_read_b64_tr_b16 v[62:63], v18 offset:9216
    v_mfma_f32_32x32x16_bf16 v[144:159], v[84:87], v[76:79], v[144:159]
    ds_read_b128 v[64:67], v14 offset:49152
    ds_read_b128 v[68:71], v14 offset:53248
    v_mfma_f32_32x32x16_bf16 v[160:175], v[72:75], v[88:91], v[160:175]
    v_mfma_f32_32x32x16_bf16 v[176:191], v[72:75], v[92:95], v[176:191]
    s_waitcnt vmcnt(7) lgkmcnt(0)
    s_barrier
    v_mfma_f32_32x32x16_bf16 v[96:111], v[56:59], v[48:51], v[96:111]
    ds_read_b64_tr_b16 v[80:81], v18 offset:4096
    ds_read_b64_tr_b16 v[82:83], v18 offset:5120
    v_mfma_f32_32x32x16_bf16 v[112:127], v[56:59], v[52:55], v[112:127]
    ds_read_b128 v[72:75], v7 offset:49152
    ds_read_b128 v[76:79], v11 offset:49152
    v_mfma_f32_32x32x16_bf16 v[128:143], v[60:63], v[48:51], v[128:143]
    ds_read_b64_tr_b16 v[84:85], v18 offset:12288
    ds_read_b64_tr_b16 v[86:87], v18 offset:13312
    v_mfma_f32_32x32x16_bf16 v[144:159], v[60:63], v[52:55], v[144:159]
    ds_read_b128 v[88:91], v15 offset:49152
    ds_read_b128 v[92:95], v15 offset:53248
    s_add_u32 s93, s82, s4
    buffer_load_dwordx4 v[192:195], v46, s[52:55], s93 offen
    s_add_u32 s93, s83, s4
    buffer_load_dwordx4 v[196:199], v46, s[52:55], s93 offen
    v_mfma_f32_32x32x16_bf16 v[160:175], v[48:51], v[64:67], v[160:175]
    v_mfma_f32_32x32x16_bf16 v[176:191], v[48:51], v[68:71], v[176:191]
    s_waitcnt lgkmcnt(0)
    v_mfma_f32_32x32x16_bf16 v[96:111], v[80:83], v[72:75], v[96:111]
    ds_read_b64_tr_b16 v[56:57], v18 offset:16384
    ds_read_b64_tr_b16 v[58:59], v18 offset:17408
    v_mfma_f32_32x32x16_bf16 v[112:127], v[80:83], v[76:79], v[112:127]
    ds_read_b128 v[48:51], v8 offset:49152
    ds_read_b128 v[52:55], v12 offset:49152
    v_mfma_f32_32x32x16_bf16 v[128:143], v[84:87], v[72:75], v[128:143]
    ds_read_b64_tr_b16 v[60:61], v18 offset:24576
    ds_read_b64_tr_b16 v[62:63], v18 offset:25600
    v_mfma_f32_32x32x16_bf16 v[144:159], v[84:87], v[76:79], v[144:159]
    ds_read_b128 v[64:67], v16 offset:49152
    ds_read_b128 v[68:71], v16 offset:53248
    s_add_u32 s93, s82, s5
    buffer_load_dwordx4 v[200:203], v46, s[52:55], s93 offen
    s_add_u32 s93, s83, s5
    buffer_load_dwordx4 v[204:207], v46, s[52:55], s93 offen
    v_mfma_f32_32x32x16_bf16 v[160:175], v[72:75], v[88:91], v[160:175]
    v_mfma_f32_32x32x16_bf16 v[176:191], v[72:75], v[92:95], v[176:191]
    s_waitcnt vmcnt(6) lgkmcnt(0)
    s_barrier
    v_mfma_f32_32x32x16_bf16 v[96:111], v[56:59], v[48:51], v[96:111]
    ds_read_b64_tr_b16 v[80:81], v18 offset:20480
    ds_read_b64_tr_b16 v[82:83], v18 offset:21504
    v_mfma_f32_32x32x16_bf16 v[112:127], v[56:59], v[52:55], v[112:127]
    ds_read_b128 v[72:75], v9 offset:49152
    ds_read_b128 v[76:79], v13 offset:49152
    v_mfma_f32_32x32x16_bf16 v[128:143], v[60:63], v[48:51], v[128:143]
    ds_read_b64_tr_b16 v[84:85], v18 offset:28672
    ds_read_b64_tr_b16 v[86:87], v18 offset:29696
    v_mfma_f32_32x32x16_bf16 v[144:159], v[60:63], v[52:55], v[144:159]
    ds_read_b128 v[88:91], v17 offset:49152
    ds_read_b128 v[92:95], v17 offset:53248
    s_add_u32 s93, s82, s6
    buffer_load_dwordx4 v[208:211], v46, s[52:55], s93 offen
    s_add_u32 s93, s83, s6
    buffer_load_dwordx4 v[212:215], v46, s[52:55], s93 offen
    v_mfma_f32_32x32x16_bf16 v[160:175], v[48:51], v[64:67], v[160:175]
    v_mfma_f32_32x32x16_bf16 v[176:191], v[48:51], v[68:71], v[176:191]
    s_waitcnt lgkmcnt(0)
    v_mfma_f32_32x32x16_bf16 v[96:111], v[80:83], v[72:75], v[96:111]
    ds_read_b64_tr_b16 v[56:57], v18 offset:32768
    ds_read_b64_tr_b16 v[58:59], v18 offset:33792
    v_mfma_f32_32x32x16_bf16 v[112:127], v[80:83], v[76:79], v[112:127]
    ds_read_b128 v[48:51], v6 offset:0
    ds_read_b128 v[52:55], v10 offset:0
    v_mfma_f32_32x32x16_bf16 v[128:143], v[84:87], v[72:75], v[128:143]
    ds_read_b64_tr_b16 v[60:61], v18 offset:40960
    ds_read_b64_tr_b16 v[62:63], v18 offset:41984
    v_mfma_f32_32x32x16_bf16 v[144:159], v[84:87], v[76:79], v[144:159]
    ds_read_b128 v[64:67], v14 offset:0
    ds_read_b128 v[68:71], v14 offset:4096
    s_add_u32 s93, s82, s7
    buffer_load_dwordx4 v[216:219], v46, s[52:55], s93 offen
    s_add_u32 s93, s83, s7
    buffer_load_dwordx4 v[220:223], v46, s[52:55], s93 offen
    v_mfma_f32_32x32x16_bf16 v[160:175], v[72:75], v[88:91], v[160:175]
    v_mfma_f32_32x32x16_bf16 v[176:191], v[72:75], v[92:95], v[176:191]
    s_waitcnt vmcnt(8) lgkmcnt(0)
    s_barrier
    v_mfma_f32_32x32x16_bf16 v[96:111], v[56:59], v[48:51], v[96:111]
    ds_read_b64_tr_b16 v[80:81], v18 offset:36864
    ds_read_b64_tr_b16 v[82:83], v18 offset:37888
    v_mfma_f32_32x32x16_bf16 v[112:127], v[56:59], v[52:55], v[112:127]
    ds_read_b128 v[72:75], v7 offset:0
    ds_read_b128 v[76:79], v11 offset:0
    v_mfma_f32_32x32x16_bf16 v[128:143], v[60:63], v[48:51], v[128:143]
    ds_read_b64_tr_b16 v[84:85], v18 offset:45056
    ds_read_b64_tr_b16 v[86:87], v18 offset:46080
    v_mfma_f32_32x32x16_bf16 v[144:159], v[60:63], v[52:55], v[144:159]
    ds_read_b128 v[88:91], v15 offset:0
    ds_read_b128 v[92:95], v15 offset:4096
    s_add_u32 s93, s82, s8
    buffer_load_dwordx4 v[224:227], v46, s[52:55], s93 offen
    s_add_u32 s93, s83, s8
    buffer_load_dwordx4 v[228:231], v46, s[52:55], s93 offen
    v_mfma_f32_32x32x16_bf16 v[160:175], v[48:51], v[64:67], v[160:175]
    v_mfma_f32_32x32x16_bf16 v[176:191], v[48:51], v[68:71], v[176:191]
    s_waitcnt lgkmcnt(0)
    v_mfma_f32_32x32x16_bf16 v[96:111], v[80:83], v[72:75], v[96:111]
    ds_read_b64_tr_b16 v[56:57], v19 offset:0
    ds_read_b64_tr_b16 v[58:59], v19 offset:1024
    v_mfma_f32_32x32x16_bf16 v[112:127], v[80:83], v[76:79], v[112:127]
    ds_read_b128 v[48:51], v8 offset:0
    ds_read_b128 v[52:55], v12 offset:0
    v_mfma_f32_32x32x16_bf16 v[128:143], v[84:87], v[72:75], v[128:143]
    ds_read_b64_tr_b16 v[60:61], v19 offset:8192
    ds_read_b64_tr_b16 v[62:63], v19 offset:9216
    v_mfma_f32_32x32x16_bf16 v[144:159], v[84:87], v[76:79], v[144:159]
    ds_read_b128 v[64:67], v16 offset:0
    ds_read_b128 v[68:71], v16 offset:4096
    s_add_u32 s93, s82, s9
    buffer_load_dwordx4 v[232:235], v46, s[52:55], s93 offen
    s_add_u32 s93, s83, s9
    buffer_load_dwordx4 v[236:239], v46, s[52:55], s93 offen
    v_mfma_f32_32x32x16_bf16 v[160:175], v[72:75], v[88:91], v[160:175]
    v_mfma_f32_32x32x16_bf16 v[176:191], v[72:75], v[92:95], v[176:191]
    s_waitcnt lgkmcnt(0)
    v_mfma_f32_32x32x16_bf16 v[96:111], v[56:59], v[48:51], v[96:111]
    ds_read_b64_tr_b16 v[80:81], v19 offset:4096
    ds_read_b64_tr_b16 v[82:83], v19 offset:5120
    v_mfma_f32_32x32x16_bf16 v[112:127], v[56:59], v[52:55], v[112:127]
    ds_read_b128 v[72:75], v9 offset:0
    ds_read_b128 v[76:79], v13 offset:0
    v_mfma_f32_32x32x16_bf16 v[128:143], v[60:63], v[48:51], v[128:143]
    ds_read_b64_tr_b16 v[84:85], v19 offset:12288
    ds_read_b64_tr_b16 v[86:87], v19 offset:13312
    v_mfma_f32_32x32x16_bf16 v[144:159], v[60:63], v[52:55], v[144:159]
    ds_read_b128 v[88:91], v17 offset:0
    ds_read_b128 v[92:95], v17 offset:4096
    s_add_u32 s93, s82, s10
    buffer_load_dwordx4 v[240:243], v46, s[52:55], s93 offen
    s_add_u32 s93, s83, s10
    buffer_load_dwordx4 v[244:247], v46, s[52:55], s93 offen
    v_mfma_f32_32x32x16_bf16 v[160:175], v[48:51], v[64:67], v[160:175]
    v_mfma_f32_32x32x16_bf16 v[176:191], v[48:51], v[68:71], v[176:191]
    s_waitcnt lgkmcnt(0)
    v_mfma_f32_32x32x16_bf16 v[96:111], v[80:83], v[72:75], v[96:111]
    v_mfma_f32_32x32x16_bf16 v[112:127], v[80:83], v[76:79], v[112:127]
    v_mfma_f32_32x32x16_bf16 v[128:143], v[84:87], v[72:75], v[128:143]
    v_mfma_f32_32x32x16_bf16 v[144:159], v[84:87], v[76:79], v[144:159]
    s_add_u32 s93, s82, s11
    buffer_load_dwordx4 v[248:251], v46, s[52:55], s93 offen
    s_add_u32 s93, s83, s11
    buffer_load_dwordx4 v[252:255], v46, s[52:55], s93 offen
    v_mfma_f32_32x32x16_bf16 v[160:175], v[72:75], v[88:91], v[160:175]
    v_mfma_f32_32x32x16_bf16 v[176:191], v[72:75], v[92:95], v[176:191]
    s_setprio 2
    s_mov_b32 s30, 1.0
    s_mov_b32 s72, 0xbdd2d3e8
    v_mov_b32 v36, 0xc0135761
    v_lshlrev_b32 v37, 4, v1
    s_lshl_b32 s75, s65, 2
    s_add_u32 s73, s75, s67
    s_xor_b32 s74, s73, 1
    s_mul_i32 s73, s73, 172032
    s_mul_i32 s74, s74, 172032
    s_lshl_b32 s75, s66, 13
    s_lshr_b32 s76, s64, 1
    s_lshl_b32 s76, s76, 11
    s_add_u32 s75, s75, s76
    s_add_u32 s76, s73, 114688
    s_add_u32 s73, s73, s75
    s_add_u32 s74, s74, s75
    s_lshl_b32 s75, s66, 12
    s_add_u32 s76, s76, s75
    v_mov_b32 v39, 157696
    ds_read_b32 v39, v39
    v_fma_f32 v30, v20, v160, v161
    v_fma_f32 v31, v20, v176, v177
    v_fma_f32 v30, -v21, v176, v30
    v_fma_f32 v31, v21, v160, v31
    v_fma_f32 v28, v20, v30, v162
    v_fma_f32 v29, v20, v31, v178
    v_fma_f32 v28, -v21, v31, v28
    v_fma_f32 v29, v21, v30, v29
    v_fma_f32 v30, v20, v28, v163
    v_fma_f32 v31, v20, v29, v179
    v_fma_f32 v30, -v21, v29, v30
    v_fma_f32 v31, v21, v28, v31
    v_fma_f32 v28, v20, v30, v164
    v_fma_f32 v29, v20, v31, v180
    v_fma_f32 v28, -v21, v31, v28
    v_fma_f32 v29, v21, v30, v29
    v_fma_f32 v30, v20, v28, v165
    v_fma_f32 v31, v20, v29, v181
    v_fma_f32 v30, -v21, v29, v30
    v_fma_f32 v31, v21, v28, v31
    v_fma_f32 v28, v20, v30, v166
    v_fma_f32 v29, v20, v31, v182
    v_fma_f32 v28, -v21, v31, v28
    v_fma_f32 v29, v21, v30, v29
    v_fma_f32 v30, v20, v28, v167
    v_fma_f32 v31, v20, v29, v183
    v_fma_f32 v30, -v21, v29, v30
    v_fma_f32 v31, v21, v28, v31
    v_fma_f32 v28, v20, v30, v168
    v_fma_f32 v29, v20, v31, v184
    v_fma_f32 v28, -v21, v31, v28
    v_fma_f32 v29, v21, v30, v29
    v_fma_f32 v30, v20, v28, v169
    v_fma_f32 v31, v20, v29, v185
    v_fma_f32 v30, -v21, v29, v30
    v_fma_f32 v31, v21, v28, v31
    v_fma_f32 v28, v20, v30, v170
    v_fma_f32 v29, v20, v31, v186
    v_fma_f32 v28, -v21, v31, v28
    v_fma_f32 v29, v21, v30, v29
    v_fma_f32 v30, v20, v28, v171
    v_fma_f32 v31, v20, v29, v187
    v_fma_f32 v30, -v21, v29, v30
    v_fma_f32 v31, v21, v28, v31
    v_fma_f32 v28, v20, v30, v172
    v_fma_f32 v29, v20, v31, v188
    v_fma_f32 v28, -v21, v31, v28
    v_fma_f32 v29, v21, v30, v29
    v_fma_f32 v30, v20, v28, v173
    v_fma_f32 v31, v20, v29, v189
    v_fma_f32 v30, -v21, v29, v30
    v_fma_f32 v31, v21, v28, v31
    v_fma_f32 v28, v20, v30, v174
    v_fma_f32 v29, v20, v31, v190
    v_fma_f32 v28, -v21, v31, v28
    v_fma_f32 v29, v21, v30, v29
    v_fma_f32 v30, v20, v28, v175
    v_fma_f32 v31, v20, v29, v191
    v_fma_f32 v30, -v21, v29, v30
    v_fma_f32 v31, v21, v28, v31
    v_and_b32 v32, 31, v1
    v_lshlrev_b32 v32, 3, v32
    s_lshl_b32 s71, s67, 9
    s_add_u32 s71, s71, 155648
    v_lshl_add_u32 v33, v1, 3, s71
    ds_write_b64 v33, v[30:31]
    v_add_u32 v33, 155648, v32
    s_waitcnt lgkmcnt(0)
    s_barrier
    ds_read_b64 v[48:49], v33 offset:0
    ds_read_b64 v[50:51], v33 offset:256
    ds_read_b64 v[52:53], v33 offset:512
    ds_read_b64 v[54:55], v33 offset:768
    ds_read_b64 v[56:57], v33 offset:1024
    ds_read_b64 v[58:59], v33 offset:1280
    ds_read_b64 v[60:61], v33 offset:1536
    ds_read_b64 v[62:63], v33 offset:1792
    s_lshl_b32 s78, s66, 13
    s_add_u32 s78, s78, 13426688
    s_add_u32 s79, s78, 4096
    v_mov_b32 v38, v32
    v_lshlrev_b32 v40, 1, v32
    v_readfirstlane_b32 s38, v39
    s_cmp_lg_u32 s64, 0
    s_cbranch_scc1 K1_NOPUB
    s_waitcnt lgkmcnt(0)
    v_fma_f32 v30, v24, v48, v50
    v_fma_f32 v31, v24, v49, v51
    v_fma_f32 v30, -v25, v49, v30
    v_fma_f32 v31, v25, v48, v31
    v_fma_f32 v28, v24, v30, v52
    v_fma_f32 v29, v24, v31, v53
    v_fma_f32 v28, -v25, v31, v28
    v_fma_f32 v29, v25, v30, v29
    v_fma_f32 v30, v24, v28, v54
    v_fma_f32 v31, v24, v29, v55
    v_fma_f32 v30, -v25, v29, v30
    v_fma_f32 v31, v25, v28, v31
    v_fma_f32 v28, v24, v30, v56
    v_fma_f32 v29, v24, v31, v57
    v_fma_f32 v28, -v25, v31, v28
    v_fma_f32 v29, v25, v30, v29
    v_fma_f32 v30, v24, v28, v58
    v_fma_f32 v31, v24, v29, v59
    v_fma_f32 v30, -v25, v29, v30
    v_fma_f32 v31, v25, v28, v31
    v_fma_f32 v28, v24, v30, v60
    v_fma_f32 v29, v24, v31, v61
    v_fma_f32 v28, -v25, v31, v28
    v_fma_f32 v29, v25, v30, v29
    v_fma_f32 v30, v24, v28, v62
    v_fma_f32 v31, v24, v29, v63
    v_fma_f32 v30, -v25, v29, v30
    v_fma_f32 v31, v25, v28, v31
    s_lshl_b32 s71, s65, 9
    s_add_u32 s71, s71, s78
    v_mov_b32 v32, v30
    v_mov_b32 v33, s38
    v_mov_b32 v34, v31
    v_mov_b32 v35, s38
    buffer_store_dwordx4 v[32:35], v40, s[52:55], s71 offen sc1
K1_NOPUB:
    v_lshrrev_b32 v18, 5, v1
    v_lshlrev_b32 v18, 6, v18
    s_lshl_b32 s71, s65, 2
    s_add_u32 s71, s71, s67
    s_lshl_b32 s71, s71, 7
    s_add_u32 s71, s71, 13418496
    buffer_load_dwordx4 v[2:5], v18, s[52:55], s71 offen offset:0 sc1
    buffer_load_dwordx4 v[6:9], v18, s[52:55], s71 offen offset:16 sc1
    buffer_load_dwordx4 v[10:13], v18, s[52:55], s71 offen offset:32 sc1
    buffer_load_dwordx4 v[14:17], v18, s[52:55], s71 offen offset:48 sc1
    v_pk_mul_f32 v[28:29], v[96:97], v[96:97]
    v_pk_mul_f32 v[30:31], v[98:99], v[98:99]
    v_pk_fma_f32 v[28:29], v[28:29], s[72:73], v[36:37] op_sel_hi:[1,0,0]
    v_pk_fma_f32 v[30:31], v[30:31], s[72:73], v[36:37] op_sel_hi:[1,0,0]
    v_pk_mul_f32 v[28:29], v[28:29], v[96:97]
    v_pk_mul_f32 v[30:31], v[30:31], v[98:99]
    v_exp_f32 v28, v28
    v_exp_f32 v29, v29
    v_exp_f32 v30, v30
    v_exp_f32 v31, v31
    v_pk_mul_f32 v[32:33], v[96:97], v[128:129]
    v_pk_mul_f32 v[34:35], v[98:99], v[130:131]
    v_pk_add_f32 v[28:29], v[28:29], s[30:31] op_sel_hi:[1,0]
    v_pk_add_f32 v[30:31], v[30:31], s[30:31] op_sel_hi:[1,0]
    v_rcp_f32 v28, v28
    v_rcp_f32 v29, v29
    v_rcp_f32 v30, v30
    v_rcp_f32 v31, v31
    v_pk_mul_f32 v[28:29], v[28:29], v[32:33]
    v_pk_mul_f32 v[30:31], v[30:31], v[34:35]
    v_cvt_pk_bf16_f32 v96, v28, v29
    v_cvt_pk_bf16_f32 v97, v30, v31
    v_pk_mul_f32 v[28:29], v[100:101], v[100:101]
    v_pk_mul_f32 v[30:31], v[102:103], v[102:103]
    v_pk_fma_f32 v[28:29], v[28:29], s[72:73], v[36:37] op_sel_hi:[1,0,0]
    v_pk_fma_f32 v[30:31], v[30:31], s[72:73], v[36:37] op_sel_hi:[1,0,0]
    v_pk_mul_f32 v[28:29], v[28:29], v[100:101]
    v_pk_mul_f32 v[30:31], v[30:31], v[102:103]
    v_exp_f32 v28, v28
    v_exp_f32 v29, v29
    v_exp_f32 v30, v30
    v_exp_f32 v31, v31
    v_pk_mul_f32 v[32:33], v[100:101], v[132:133]
    v_pk_mul_f32 v[34:35], v[102:103], v[134:135]
    v_pk_add_f32 v[28:29], v[28:29], s[30:31] op_sel_hi:[1,0]
    v_pk_add_f32 v[30:31], v[30:31], s[30:31] op_sel_hi:[1,0]
    v_rcp_f32 v28, v28
    v_rcp_f32 v29, v29
    v_rcp_f32 v30, v30
    v_rcp_f32 v31, v31
    v_pk_mul_f32 v[28:29], v[28:29], v[32:33]
    v_pk_mul_f32 v[30:31], v[30:31], v[34:35]
    v_cvt_pk_bf16_f32 v98, v28, v29
    v_cvt_pk_bf16_f32 v99, v30, v31
    v_pk_mul_f32 v[28:29], v[104:105], v[104:105]
    v_pk_mul_f32 v[30:31], v[106:107], v[106:107]
    v_pk_fma_f32 v[28:29], v[28:29], s[72:73], v[36:37] op_sel_hi:[1,0,0]
    v_pk_fma_f32 v[30:31], v[30:31], s[72:73], v[36:37] op_sel_hi:[1,0,0]
    v_pk_mul_f32 v[28:29], v[28:29], v[104:105]
    v_pk_mul_f32 v[30:31], v[30:31], v[106:107]
    v_exp_f32 v28, v28
    v_exp_f32 v29, v29
    v_exp_f32 v30, v30
    v_exp_f32 v31, v31
    v_pk_mul_f32 v[32:33], v[104:105], v[136:137]
    v_pk_mul_f32 v[34:35], v[106:107], v[138:139]
    v_pk_add_f32 v[28:29], v[28:29], s[30:31] op_sel_hi:[1,0]
    v_pk_add_f32 v[30:31], v[30:31], s[30:31] op_sel_hi:[1,0]
    v_rcp_f32 v28, v28
    v_rcp_f32 v29, v29
    v_rcp_f32 v30, v30
    v_rcp_f32 v31, v31
    v_pk_mul_f32 v[28:29], v[28:29], v[32:33]
    v_pk_mul_f32 v[30:31], v[30:31], v[34:35]
    v_cvt_pk_bf16_f32 v100, v28, v29
    v_cvt_pk_bf16_f32 v101, v30, v31
    v_pk_mul_f32 v[28:29], v[108:109], v[108:109]
    v_pk_mul_f32 v[30:31], v[110:111], v[110:111]
    v_pk_fma_f32 v[28:29], v[28:29], s[72:73], v[36:37] op_sel_hi:[1,0,0]
    v_pk_fma_f32 v[30:31], v[30:31], s[72:73], v[36:37] op_sel_hi:[1,0,0]
    v_pk_mul_f32 v[28:29], v[28:29], v[108:109]
    v_pk_mul_f32 v[30:31], v[30:31], v[110:111]
    v_exp_f32 v28, v28
    v_exp_f32 v29, v29
    v_exp_f32 v30, v30
    v_exp_f32 v31, v31
    v_pk_mul_f32 v[32:33], v[108:109], v[140:141]
    v_pk_mul_f32 v[34:35], v[110:111], v[142:143]
    v_pk_add_f32 v[28:29], v[28:29], s[30:31] op_sel_hi:[1,0]
    v_pk_add_f32 v[30:31], v[30:31], s[30:31] op_sel_hi:[1,0]
    v_rcp_f32 v28, v28
    v_rcp_f32 v29, v29
    v_rcp_f32 v30, v30
    v_rcp_f32 v31, v31
    v_pk_mul_f32 v[28:29], v[28:29], v[32:33]
    v_pk_mul_f32 v[30:31], v[30:31], v[34:35]
    v_cvt_pk_bf16_f32 v102, v28, v29
    v_cvt_pk_bf16_f32 v103, v30, v31
    v_pk_mul_f32 v[28:29], v[112:113], v[112:113]
    v_pk_mul_f32 v[30:31], v[114:115], v[114:115]
    v_pk_fma_f32 v[28:29], v[28:29], s[72:73], v[36:37] op_sel_hi:[1,0,0]
    v_pk_fma_f32 v[30:31], v[30:31], s[72:73], v[36:37] op_sel_hi:[1,0,0]
    v_pk_mul_f32 v[28:29], v[28:29], v[112:113]
    v_pk_mul_f32 v[30:31], v[30:31], v[114:115]
    v_exp_f32 v28, v28
    v_exp_f32 v29, v29
    v_exp_f32 v30, v30
    v_exp_f32 v31, v31
    v_pk_mul_f32 v[32:33], v[112:113], v[144:145]
    v_pk_mul_f32 v[34:35], v[114:115], v[146:147]
    v_pk_add_f32 v[28:29], v[28:29], s[30:31] op_sel_hi:[1,0]
    v_pk_add_f32 v[30:31], v[30:31], s[30:31] op_sel_hi:[1,0]
    v_rcp_f32 v28, v28
    v_rcp_f32 v29, v29
    v_rcp_f32 v30, v30
    v_rcp_f32 v31, v31
    v_pk_mul_f32 v[28:29], v[28:29], v[32:33]
    v_pk_mul_f32 v[30:31], v[30:31], v[34:35]
    v_cvt_pk_bf16_f32 v112, v28, v29
    v_cvt_pk_bf16_f32 v113, v30, v31
    v_pk_mul_f32 v[28:29], v[116:117], v[116:117]
    v_pk_mul_f32 v[30:31], v[118:119], v[118:119]
    v_pk_fma_f32 v[28:29], v[28:29], s[72:73], v[36:37] op_sel_hi:[1,0,0]
    v_pk_fma_f32 v[30:31], v[30:31], s[72:73], v[36:37] op_sel_hi:[1,0,0]
    v_pk_mul_f32 v[28:29], v[28:29], v[116:117]
    v_pk_mul_f32 v[30:31], v[30:31], v[118:119]
    v_exp_f32 v28, v28
    v_exp_f32 v29, v29
    v_exp_f32 v30, v30
    v_exp_f32 v31, v31
    v_pk_mul_f32 v[32:33], v[116:117], v[148:149]
    v_pk_mul_f32 v[34:35], v[118:119], v[150:151]
    v_pk_add_f32 v[28:29], v[28:29], s[30:31] op_sel_hi:[1,0]
    v_pk_add_f32 v[30:31], v[30:31], s[30:31] op_sel_hi:[1,0]
    v_rcp_f32 v28, v28
    v_rcp_f32 v29, v29
    v_rcp_f32 v30, v30
    v_rcp_f32 v31, v31
    v_pk_mul_f32 v[28:29], v[28:29], v[32:33]
    v_pk_mul_f32 v[30:31], v[30:31], v[34:35]
    v_cvt_pk_bf16_f32 v114, v28, v29
    v_cvt_pk_bf16_f32 v115, v30, v31
    v_pk_mul_f32 v[28:29], v[120:121], v[120:121]
    v_pk_mul_f32 v[30:31], v[122:123], v[122:123]
    v_pk_fma_f32 v[28:29], v[28:29], s[72:73], v[36:37] op_sel_hi:[1,0,0]
    v_pk_fma_f32 v[30:31], v[30:31], s[72:73], v[36:37] op_sel_hi:[1,0,0]
    v_pk_mul_f32 v[28:29], v[28:29], v[120:121]
    v_pk_mul_f32 v[30:31], v[30:31], v[122:123]
    v_exp_f32 v28, v28
    v_exp_f32 v29, v29
    v_exp_f32 v30, v30
    v_exp_f32 v31, v31
    v_pk_mul_f32 v[32:33], v[120:121], v[152:153]
    v_pk_mul_f32 v[34:35], v[122:123], v[154:155]
    v_pk_add_f32 v[28:29], v[28:29], s[30:31] op_sel_hi:[1,0]
    v_pk_add_f32 v[30:31], v[30:31], s[30:31] op_sel_hi:[1,0]
    v_rcp_f32 v28, v28
    v_rcp_f32 v29, v29
    v_rcp_f32 v30, v30
    v_rcp_f32 v31, v31
    v_pk_mul_f32 v[28:29], v[28:29], v[32:33]
    v_pk_mul_f32 v[30:31], v[30:31], v[34:35]
    v_cvt_pk_bf16_f32 v116, v28, v29
    v_cvt_pk_bf16_f32 v117, v30, v31
    v_pk_mul_f32 v[28:29], v[124:125], v[124:125]
    v_pk_mul_f32 v[30:31], v[126:127], v[126:127]
    v_pk_fma_f32 v[28:29], v[28:29], s[72:73], v[36:37] op_sel_hi:[1,0,0]
    v_pk_fma_f32 v[30:31], v[30:31], s[72:73], v[36:37] op_sel_hi:[1,0,0]
    v_pk_mul_f32 v[28:29], v[28:29], v[124:125]
    v_pk_mul_f32 v[30:31], v[30:31], v[126:127]
    v_exp_f32 v28, v28
    v_exp_f32 v29, v29
    v_exp_f32 v30, v30
    v_exp_f32 v31, v31
    v_pk_mul_f32 v[32:33], v[124:125], v[156:157]
    v_pk_mul_f32 v[34:35], v[126:127], v[158:159]
    v_pk_add_f32 v[28:29], v[28:29], s[30:31] op_sel_hi:[1,0]
    v_pk_add_f32 v[30:31], v[30:31], s[30:31] op_sel_hi:[1,0]
    v_rcp_f32 v28, v28
    v_rcp_f32 v29, v29
    v_rcp_f32 v30, v30
    v_rcp_f32 v31, v31
    v_pk_mul_f32 v[28:29], v[28:29], v[32:33]
    v_pk_mul_f32 v[30:31], v[30:31], v[34:35]
    v_cvt_pk_bf16_f32 v118, v28, v29
    v_cvt_pk_bf16_f32 v119, v30, v31
    s_mov_b32 s81, 0
K1_LBP:
    s_cmp_le_u32 s65, 0
    s_cbranch_scc1 K1_LBL
    buffer_load_dwordx4 v[64:67], v40, s[52:55], s78 offen offset:0 sc1
    s_cmp_le_u32 s65, 1
    s_cbranch_scc1 K1_LBL
    buffer_load_dwordx4 v[68:71], v40, s[52:55], s78 offen offset:512 sc1
    s_cmp_le_u32 s65, 2
    s_cbranch_scc1 K1_LBL
    buffer_load_dwordx4 v[72:75], v40, s[52:55], s78 offen offset:1024 sc1
    s_cmp_le_u32 s65, 3
    s_cbranch_scc1 K1_LBL
    buffer_load_dwordx4 v[76:79], v40, s[52:55], s78 offen offset:1536 sc1
    s_cmp_le_u32 s65, 4
    s_cbranch_scc1 K1_LBL
    buffer_load_dwordx4 v[80:83], v40, s[52:55], s78 offen offset:2048 sc1
    s_cmp_le_u32 s65, 5
    s_cbranch_scc1 K1_LBL
    buffer_load_dwordx4 v[84:87], v40, s[52:55], s78 offen offset:2560 sc1
    s_cmp_le_u32 s65, 6
    s_cbranch_scc1 K1_LBL
    buffer_load_dwordx4 v[88:91], v40, s[52:55], s78 offen offset:3072 sc1
    s_cmp_le_u32 s65, 7
    s_cbranch_scc1 K1_LBL
    buffer_load_dwordx4 v[92:95], v40, s[52:55], s78 offen offset:3584 sc1
    s_cmp_le_u32 s65, 8
    s_cbranch_scc1 K1_LBL
    buffer_load_dwordx4 v[128:131], v40, s[52:55], s79 offen offset:0 sc1
    s_cmp_le_u32 s65, 9
    s_cbranch_scc1 K1_LBL
    buffer_load_dwordx4 v[132:135], v40, s[52:55], s79 offen offset:512 sc1
    s_cmp_le_u32 s65, 10
    s_cbranch_scc1 K1_LBL
    buffer_load_dwordx4 v[136:139], v40, s[52:55], s79 offen offset:1024 sc1
    s_cmp_le_u32 s65, 11
    s_cbranch_scc1 K1_LBL
    buffer_load_dwordx4 v[140:143], v40, s[52:55], s79 offen offset:1536 sc1
    s_cmp_le_u32 s65, 12
    s_cbranch_scc1 K1_LBL
    buffer_load_dwordx4 v[144:147], v40, s[52:55], s79 offen offset:2048 sc1
    s_cmp_le_u32 s65, 13
    s_cbranch_scc1 K1_LBL
    buffer_load_dwordx4 v[148:151], v40, s[52:55], s79 offen offset:2560 sc1
    s_cmp_le_u32 s65, 14
    s_cbranch_scc1 K1_LBL
    buffer_load_dwordx4 v[152:155], v40, s[52:55], s79 offen offset:3072 sc1
K1_LBL:
    v_mov_b32 v34, 0
    s_waitcnt vmcnt(0)
    s_cmp_le_u32 s65, 0
    s_cbranch_scc1 K1_LBC
    v_xor_b32 v35, s38, v65
    v_xor_b32 v28, s38, v67
    v_or3_b32 v34, v34, v35, v28
    s_cmp_le_u32 s65, 1
    s_cbranch_scc1 K1_LBC
    v_xor_b32 v35, s38, v69
    v_xor_b32 v28, s38, v71
    v_or3_b32 v34, v34, v35, v28
    s_cmp_le_u32 s65, 2
    s_cbranch_scc1 K1_LBC
    v_xor_b32 v35, s38, v73
    v_xor_b32 v28, s38, v75
    v_or3_b32 v34, v34, v35, v28
    s_cmp_le_u32 s65, 3
    s_cbranch_scc1 K1_LBC
    v_xor_b32 v35, s38, v77
    v_xor_b32 v28, s38, v79
    v_or3_b32 v34, v34, v35, v28
    s_cmp_le_u32 s65, 4
    s_cbranch_scc1 K1_LBC
    v_xor_b32 v35, s38, v81
    v_xor_b32 v28, s38, v83
    v_or3_b32 v34, v34, v35, v28
    s_cmp_le_u32 s65, 5
    s_cbranch_scc1 K1_LBC
    v_xor_b32 v35, s38, v85
    v_xor_b32 v28, s38, v87
    v_or3_b32 v34, v34, v35, v28
    s_cmp_le_u32 s65, 6
    s_cbranch_scc1 K1_LBC
    v_xor_b32 v35, s38, v89
    v_xor_b32 v28, s38, v91
    v_or3_b32 v34, v34, v35, v28
    s_cmp_le_u32 s65, 7
    s_cbranch_scc1 K1_LBC
    v_xor_b32 v35, s38, v93
    v_xor_b32 v28, s38, v95
    v_or3_b32 v34, v34, v35, v28
    s_cmp_le_u32 s65, 8
    s_cbranch_scc1 K1_LBC
    v_xor_b32 v35, s38, v129
    v_xor_b32 v28, s38, v131
    v_or3_b32 v34, v34, v35, v28
    s_cmp_le_u32 s65, 9
    s_cbranch_scc1 K1_LBC
    v_xor_b32 v35, s38, v133
    v_xor_b32 v28, s38, v135
    v_or3_b32 v34, v34, v35, v28
    s_cmp_le_u32 s65, 10
    s_cbranch_scc1 K1_LBC
    v_xor_b32 v35, s38, v137
    v_xor_b32 v28, s38, v139
    v_or3_b32 v34, v34, v35, v28
    s_cmp_le_u32 s65, 11
    s_cbranch_scc1 K1_LBC
    v_xor_b32 v35, s38, v141
    v_xor_b32 v28, s38, v143
    v_or3_b32 v34, v34, v35, v28
    s_cmp_le_u32 s65, 12
    s_cbranch_scc1 K1_LBC
    v_xor_b32 v35, s38, v145
    v_xor_b32 v28, s38, v147
    v_or3_b32 v34, v34, v35, v28
    s_cmp_le_u32 s65, 13
    s_cbranch_scc1 K1_LBC
    v_xor_b32 v35, s38, v149
    v_xor_b32 v28, s38, v151
    v_or3_b32 v34, v34, v35, v28
    s_cmp_le_u32 s65, 14
    s_cbranch_scc1 K1_LBC
    v_xor_b32 v35, s38, v153
    v_xor_b32 v28, s38, v155
    v_or3_b32 v34, v34, v35, v28
K1_LBC:
    v_cmp_ne_u32 vcc, 0, v34
    s_nop 4
    s_or_b32 s71, vcc_lo, vcc_hi
    s_cbranch_scc0 K1_LBK
    s_add_u32 s81, s81, 1
    s_cmp_gt_u32 s81, 0x10000
    s_cbranch_scc1 K1_LBK
    s_sleep 1
    s_branch K1_LBP
K1_LBK:
    buffer_store_dwordx4 v[96:99], v37, s[52:55], s73 offen sc1
    buffer_store_dwordx4 v[100:103], v37, s[52:55], s73 offen offset:1024 sc1
    buffer_store_dwordx4 v[112:115], v37, s[52:55], s74 offen sc1
    buffer_store_dwordx4 v[116:119], v37, s[52:55], s74 offen offset:1024 sc1
    v_mov_b32 v28, 0
    v_mov_b32 v29, 0
    v_lshrrev_b32 v34, 5, v1
    s_lshl_b32 s71, s67, 1
    v_add_u32 v34, s71, v34
    s_waitcnt lgkmcnt(0)
    s_cmp_eq_u32 s65, 0
    s_cbranch_scc1 K1_LBD
    s_cmp_le_u32 s65, 1
    s_cbranch_scc1 K1_LX1
    v_fma_f32 v68, v26, v64, v68
    v_fma_f32 v70, v26, v66, v70
    v_fma_f32 v68, -v27, v66, v68
    v_fma_f32 v70, v27, v64, v70
    s_cmp_le_u32 s65, 2
    s_cbranch_scc1 K1_LX2
    v_fma_f32 v72, v26, v68, v72
    v_fma_f32 v74, v26, v70, v74
    v_fma_f32 v72, -v27, v70, v72
    v_fma_f32 v74, v27, v68, v74
    s_cmp_le_u32 s65, 3
    s_cbranch_scc1 K1_LX3
    v_fma_f32 v76, v26, v72, v76
    v_fma_f32 v78, v26, v74, v78
    v_fma_f32 v76, -v27, v74, v76
    v_fma_f32 v78, v27, v72, v78
    s_cmp_le_u32 s65, 4
    s_cbranch_scc1 K1_LX4
    v_fma_f32 v80, v26, v76, v80
    v_fma_f32 v82, v26, v78, v82
    v_fma_f32 v80, -v27, v78, v80
    v_fma_f32 v82, v27, v76, v82
    s_cmp_le_u32 s65, 5
    s_cbranch_scc1 K1_LX5
    v_fma_f32 v84, v26, v80, v84
    v_fma_f32 v86, v26, v82, v86
    v_fma_f32 v84, -v27, v82, v84
    v_fma_f32 v86, v27, v80, v86
    s_cmp_le_u32 s65, 6
    s_cbranch_scc1 K1_LX6
    v_fma_f32 v88, v26, v84, v88
    v_fma_f32 v90, v26, v86, v90
    v_fma_f32 v88, -v27, v86, v88
    v_fma_f32 v90, v27, v84, v90
    s_cmp_le_u32 s65, 7
    s_cbranch_scc1 K1_LX7
    v_fma_f32 v92, v26, v88, v92
    v_fma_f32 v94, v26, v90, v94
    v_fma_f32 v92, -v27, v90, v92
    v_fma_f32 v94, v27, v88, v94
    s_cmp_le_u32 s65, 8
    s_cbranch_scc1 K1_LX8
    v_fma_f32 v128, v26, v92, v128
    v_fma_f32 v130, v26, v94, v130
    v_fma_f32 v128, -v27, v94, v128
    v_fma_f32 v130, v27, v92, v130
    s_cmp_le_u32 s65, 9
    s_cbranch_scc1 K1_LX9
    v_fma_f32 v132, v26, v128, v132
    v_fma_f32 v134, v26, v130, v134
    v_fma_f32 v132, -v27, v130, v132
    v_fma_f32 v134, v27, v128, v134
    s_cmp_le_u32 s65, 10
    s_cbranch_scc1 K1_LX10
    v_fma_f32 v136, v26, v132, v136
    v_fma_f32 v138, v26, v134, v138
    v_fma_f32 v136, -v27, v134, v136
    v_fma_f32 v138, v27, v132, v138
    s_cmp_le_u32 s65, 11
    s_cbranch_scc1 K1_LX11
    v_fma_f32 v140, v26, v136, v140
    v_fma_f32 v142, v26, v138, v142
    v_fma_f32 v140, -v27, v138, v140
    v_fma_f32 v142, v27, v136, v142
    s_cmp_le_u32 s65, 12
    s_cbranch_scc1 K1_LX12
    v_fma_f32 v144, v26, v140, v144
    v_fma_f32 v146, v26, v142, v146
    v_fma_f32 v144, -v27, v142, v144
    v_fma_f32 v146, v27, v140, v146
    s_cmp_le_u32 s65, 13
    s_cbranch_scc1 K1_LX13
    v_fma_f32 v148, v26, v144, v148
    v_fma_f32 v150, v26, v146, v150
    v_fma_f32 v148, -v27, v146, v148
    v_fma_f32 v150, v27, v144, v150
    s_cmp_le_u32 s65, 14
    s_cbranch_scc1 K1_LX14
    v_fma_f32 v152, v26, v148, v152
    v_fma_f32 v154, v26, v150, v154
    v_fma_f32 v152, -v27, v150, v152
    v_fma_f32 v154, v27, v148, v154
    v_mov_b32 v28, v152
    v_mov_b32 v29, v154
K1_LBD:
    v_cmp_lt_u32 vcc, 0, v34
    v_fma_f32 v30, v24, v28, v48
    v_fma_f32 v31, v24, v29, v49
    v_fma_f32 v30, -v25, v29, v30
    v_fma_f32 v31, v25, v28, v31
    v_cndmask_b32 v28, v28, v30, vcc
    v_cndmask_b32 v29, v29, v31, vcc
    v_cmp_lt_u32 vcc, 1, v34
    v_fma_f32 v30, v24, v28, v50
    v_fma_f32 v31, v24, v29, v51
    v_fma_f32 v30, -v25, v29, v30
    v_fma_f32 v31, v25, v28, v31
    v_cndmask_b32 v28, v28, v30, vcc
    v_cndmask_b32 v29, v29, v31, vcc
    v_cmp_lt_u32 vcc, 2, v34
    v_fma_f32 v30, v24, v28, v52
    v_fma_f32 v31, v24, v29, v53
    v_fma_f32 v30, -v25, v29, v30
    v_fma_f32 v31, v25, v28, v31
    v_cndmask_b32 v28, v28, v30, vcc
    v_cndmask_b32 v29, v29, v31, vcc
    v_cmp_lt_u32 vcc, 3, v34
    v_fma_f32 v30, v24, v28, v54
    v_fma_f32 v31, v24, v29, v55
    v_fma_f32 v30, -v25, v29, v30
    v_fma_f32 v31, v25, v28, v31
    v_cndmask_b32 v28, v28, v30, vcc
    v_cndmask_b32 v29, v29, v31, vcc
    v_cmp_lt_u32 vcc, 4, v34
    v_fma_f32 v30, v24, v28, v56
    v_fma_f32 v31, v24, v29, v57
    v_fma_f32 v30, -v25, v29, v30
    v_fma_f32 v31, v25, v28, v31
    v_cndmask_b32 v28, v28, v30, vcc
    v_cndmask_b32 v29, v29, v31, vcc
    v_cmp_lt_u32 vcc, 5, v34
    v_fma_f32 v30, v24, v28, v58
    v_fma_f32 v31, v24, v29, v59
    v_fma_f32 v30, -v25, v29, v30
    v_fma_f32 v31, v25, v28, v31
    v_cndmask_b32 v28, v28, v30, vcc
    v_cndmask_b32 v29, v29, v31, vcc
    v_cmp_lt_u32 vcc, 6, v34
    v_fma_f32 v30, v24, v28, v60
    v_fma_f32 v31, v24, v29, v61
    v_fma_f32 v30, -v25, v29, v30
    v_fma_f32 v31, v25, v28, v31
    v_cndmask_b32 v28, v28, v30, vcc
    v_cndmask_b32 v29, v29, v31, vcc
    s_add_u32 s93, s82, s17
    buffer_load_dwordx4 v[80:83], v46, s[52:55], s93 offen
    s_add_u32 s93, s83, s17
    buffer_load_dwordx4 v[84:87], v46, s[52:55], s93 offen
    s_add_u32 s93, s84, s18
    buffer_load_dwordx4 v[88:91], v46, s[52:55], s93 offen
    s_add_u32 s93, s85, s18
    buffer_load_dwordx4 v[92:95], v46, s[52:55], s93 offen
    v_fma_f32 v160, v20, v28, v160
    v_fma_f32 v176, v20, v29, v176
    v_fma_f32 v160, -v21, v29, v160
    v_fma_f32 v176, v21, v28, v176
    v_fma_f32 v161, v20, v160, v161
    v_fma_f32 v177, v20, v176, v177
    v_fma_f32 v161, -v21, v176, v161
    v_fma_f32 v177, v21, v160, v177
    v_fma_f32 v162, v20, v161, v162
    v_fma_f32 v178, v20, v177, v178
    v_fma_f32 v162, -v21, v177, v162
    v_fma_f32 v178, v21, v161, v178
    v_fma_f32 v163, v20, v162, v163
    v_fma_f32 v179, v20, v178, v179
    v_fma_f32 v163, -v21, v178, v163
    v_fma_f32 v179, v21, v162, v179
    v_fma_f32 v164, v20, v163, v164
    v_fma_f32 v180, v20, v179, v180
    v_fma_f32 v164, -v21, v179, v164
    v_fma_f32 v180, v21, v163, v180
    v_fma_f32 v165, v20, v164, v165
    v_fma_f32 v181, v20, v180, v181
    v_fma_f32 v165, -v21, v180, v165
    v_fma_f32 v181, v21, v164, v181
    v_fma_f32 v166, v20, v165, v166
    v_fma_f32 v182, v20, v181, v182
    v_fma_f32 v166, -v21, v181, v166
    v_fma_f32 v182, v21, v165, v182
    v_fma_f32 v167, v20, v166, v167
    v_fma_f32 v183, v20, v182, v183
    v_fma_f32 v167, -v21, v182, v167
    v_fma_f32 v183, v21, v166, v183
    v_fma_f32 v168, v20, v167, v168
    v_fma_f32 v184, v20, v183, v184
    v_fma_f32 v168, -v21, v183, v168
    v_fma_f32 v184, v21, v167, v184
    v_fma_f32 v169, v20, v168, v169
    v_fma_f32 v185, v20, v184, v185
    v_fma_f32 v169, -v21, v184, v169
    v_fma_f32 v185, v21, v168, v185
    v_fma_f32 v170, v20, v169, v170
    v_fma_f32 v186, v20, v185, v186
    v_fma_f32 v170, -v21, v185, v170
    v_fma_f32 v186, v21, v169, v186
    v_fma_f32 v171, v20, v170, v171
    v_fma_f32 v187, v20, v186, v187
    v_fma_f32 v171, -v21, v186, v171
    v_fma_f32 v187, v21, v170, v187
    v_fma_f32 v172, v20, v171, v172
    v_fma_f32 v188, v20, v187, v188
    v_fma_f32 v172, -v21, v187, v172
    v_fma_f32 v188, v21, v171, v188
    v_fma_f32 v173, v20, v172, v173
    v_fma_f32 v189, v20, v188, v189
    v_fma_f32 v173, -v21, v188, v173
    v_fma_f32 v189, v21, v172, v189
    v_fma_f32 v174, v20, v173, v174
    v_fma_f32 v190, v20, v189, v190
    v_fma_f32 v174, -v21, v189, v174
    v_fma_f32 v190, v21, v173, v190
    v_fma_f32 v175, v20, v174, v175
    v_fma_f32 v191, v20, v190, v191
    v_fma_f32 v175, -v21, v190, v175
    v_fma_f32 v191, v21, v174, v191
    v_pk_mul_f32 v[32:33], v[22:23], v[2:3] op_sel_hi:[0,1]
    v_pk_mul_f32 v[34:35], v[22:23], v[2:3] op_sel:[1,0]
    v_pk_mul_f32 v[28:29], v[32:33], v[160:161]
    v_pk_mul_f32 v[30:31], v[32:33], v[176:177]
    v_pk_fma_f32 v[28:29], v[34:35], v[176:177], v[28:29] neg_lo:[1,0,0] neg_hi:[1,0,0]
    v_pk_fma_f32 v[30:31], v[34:35], v[160:161], v[30:31] neg_lo:[1,0,1] neg_hi:[1,0,1]
    v_cvt_pk_bf16_f32 v64, v28, v29
    v_cvt_pk_bf16_f32 v72, v30, v31
    v_pk_mul_f32 v[32:33], v[22:23], v[4:5] op_sel_hi:[0,1]
    v_pk_mul_f32 v[34:35], v[22:23], v[4:5] op_sel:[1,0]
    v_pk_mul_f32 v[28:29], v[32:33], v[162:163]
    v_pk_mul_f32 v[30:31], v[32:33], v[178:179]
    v_pk_fma_f32 v[28:29], v[34:35], v[178:179], v[28:29] neg_lo:[1,0,0] neg_hi:[1,0,0]
    v_pk_fma_f32 v[30:31], v[34:35], v[162:163], v[30:31] neg_lo:[1,0,1] neg_hi:[1,0,1]
    v_cvt_pk_bf16_f32 v65, v28, v29
    v_cvt_pk_bf16_f32 v73, v30, v31
    v_pk_mul_f32 v[32:33], v[22:23], v[6:7] op_sel_hi:[0,1]
    v_pk_mul_f32 v[34:35], v[22:23], v[6:7] op_sel:[1,0]
    v_pk_mul_f32 v[28:29], v[32:33], v[164:165]
    v_pk_mul_f32 v[30:31], v[32:33], v[180:181]
    v_pk_fma_f32 v[28:29], v[34:35], v[180:181], v[28:29] neg_lo:[1,0,0] neg_hi:[1,0,0]
    v_pk_fma_f32 v[30:31], v[34:35], v[164:165], v[30:31] neg_lo:[1,0,1] neg_hi:[1,0,1]
    v_cvt_pk_bf16_f32 v66, v28, v29
    v_cvt_pk_bf16_f32 v74, v30, v31
    v_pk_mul_f32 v[32:33], v[22:23], v[8:9] op_sel_hi:[0,1]
    v_pk_mul_f32 v[34:35], v[22:23], v[8:9] op_sel:[1,0]
    v_pk_mul_f32 v[28:29], v[32:33], v[166:167]
    v_pk_mul_f32 v[30:31], v[32:33], v[182:183]
    v_pk_fma_f32 v[28:29], v[34:35], v[182:183], v[28:29] neg_lo:[1,0,0] neg_hi:[1,0,0]
    v_pk_fma_f32 v[30:31], v[34:35], v[166:167], v[30:31] neg_lo:[1,0,1] neg_hi:[1,0,1]
    v_cvt_pk_bf16_f32 v67, v28, v29
    v_cvt_pk_bf16_f32 v75, v30, v31
    v_pk_mul_f32 v[32:33], v[22:23], v[10:11] op_sel_hi:[0,1]
    v_pk_mul_f32 v[34:35], v[22:23], v[10:11] op_sel:[1,0]
    v_pk_mul_f32 v[28:29], v[32:33], v[168:169]
    v_pk_mul_f32 v[30:31], v[32:33], v[184:185]
    v_pk_fma_f32 v[28:29], v[34:35], v[184:185], v[28:29] neg_lo:[1,0,0] neg_hi:[1,0,0]
    v_pk_fma_f32 v[30:31], v[34:35], v[168:169], v[30:31] neg_lo:[1,0,1] neg_hi:[1,0,1]
    v_cvt_pk_bf16_f32 v68, v28, v29
    v_cvt_pk_bf16_f32 v76, v30, v31
    v_pk_mul_f32 v[32:33], v[22:23], v[12:13] op_sel_hi:[0,1]
    v_pk_mul_f32 v[34:35], v[22:23], v[12:13] op_sel:[1,0]
    v_pk_mul_f32 v[28:29], v[32:33], v[170:171]
    v_pk_mul_f32 v[30:31], v[32:33], v[186:187]
    v_pk_fma_f32 v[28:29], v[34:35], v[186:187], v[28:29] neg_lo:[1,0,0] neg_hi:[1,0,0]
    v_pk_fma_f32 v[30:31], v[34:35], v[170:171], v[30:31] neg_lo:[1,0,1] neg_hi:[1,0,1]
    v_cvt_pk_bf16_f32 v69, v28, v29
    v_cvt_pk_bf16_f32 v77, v30, v31
    v_pk_mul_f32 v[32:33], v[22:23], v[14:15] op_sel_hi:[0,1]
    v_pk_mul_f32 v[34:35], v[22:23], v[14:15] op_sel:[1,0]
    v_pk_mul_f32 v[28:29], v[32:33], v[172:173]
    v_pk_mul_f32 v[30:31], v[32:33], v[188:189]
    v_pk_fma_f32 v[28:29], v[34:35], v[188:189], v[28:29] neg_lo:[1,0,0] neg_hi:[1,0,0]
    v_pk_fma_f32 v[30:31], v[34:35], v[172:173], v[30:31] neg_lo:[1,0,1] neg_hi:[1,0,1]
    v_cvt_pk_bf16_f32 v70, v28, v29
    v_cvt_pk_bf16_f32 v78, v30, v31
    v_pk_mul_f32 v[32:33], v[22:23], v[16:17] op_sel_hi:[0,1]
    v_pk_mul_f32 v[34:35], v[22:23], v[16:17] op_sel:[1,0]
    v_pk_mul_f32 v[28:29], v[32:33], v[174:175]
    v_pk_mul_f32 v[30:31], v[32:33], v[190:191]
    v_pk_fma_f32 v[28:29], v[34:35], v[190:191], v[28:29] neg_lo:[1,0,0] neg_hi:[1,0,0]
    v_pk_fma_f32 v[30:31], v[34:35], v[174:175], v[30:31] neg_lo:[1,0,1] neg_hi:[1,0,1]
    v_cvt_pk_bf16_f32 v71, v28, v29
    v_cvt_pk_bf16_f32 v79, v30, v31
    s_lshl_b32 s71, s64, 12
    s_add_u32 s71, s71, 131072
    v_lshrrev_b32 v28, 5, v1
    v_lshlrev_b32 v29, 5, v28
    v_lshl_add_u32 v29, v38, 3, v29
    v_add_u32 v29, s71, v29
    ds_write_b128 v29, v[64:67]
    ds_write_b128 v29, v[68:71] offset:16
    ds_write_b128 v29, v[72:75] offset:2048
    ds_write_b128 v29, v[76:79] offset:2064
    v_bfe_u32 v30, v1, 2, 2
    v_lshl_add_u32 v30, v28, 3, v30
    v_lshlrev_b32 v30, 6, v30
    v_and_b32 v31, 1, v1
    v_lshl_add_u32 v30, v31, 5, v30
    v_bfe_u32 v31, v1, 4, 1
    v_lshl_add_u32 v30, v31, 4, v30
    v_bfe_u32 v31, v1, 1, 1
    v_lshl_add_u32 v30, v31, 3, v30
    v_add_u32 v30, s71, v30
    s_waitcnt lgkmcnt(0)
    s_add_u32 s93, s82, s16
    buffer_load_dwordx4 v[72:75], v46, s[52:55], s93 offen
    s_add_u32 s93, s83, s16
    buffer_load_dwordx4 v[76:79], v46, s[52:55], s93 offen
    ds_read_b64_tr_b16 v[160:161], v30 offset:0
    ds_read_b64_tr_b16 v[162:163], v30 offset:256
    ds_read_b64_tr_b16 v[164:165], v30 offset:1024
    ds_read_b64_tr_b16 v[166:167], v30 offset:1280
    ds_read_b64_tr_b16 v[168:169], v30 offset:2048
    ds_read_b64_tr_b16 v[170:171], v30 offset:2304
    ds_read_b64_tr_b16 v[172:173], v30 offset:3072
    ds_read_b64_tr_b16 v[174:175], v30 offset:3328
    s_waitcnt lgkmcnt(6)
    buffer_store_dwordx4 v[160:163], v37, s[52:55], s76 offen offset:0 sc1
    s_waitcnt lgkmcnt(4)
    buffer_store_dwordx4 v[164:167], v37, s[52:55], s76 offen offset:1024 sc1
    s_waitcnt lgkmcnt(2)
    buffer_store_dwordx4 v[168:171], v37, s[52:55], s76 offen offset:2048 sc1
    s_waitcnt lgkmcnt(0)
    buffer_store_dwordx4 v[172:175], v37, s[52:55], s76 offen offset:3072 sc1
    s_setprio 0
    s_branch K1_JOIN
CKSN:
    s_mov_b32 s81, 0
POLL0:
    buffer_load_dwordx2 v[42:43], v44, s[56:59], 0 offen sc1
    s_waitcnt vmcnt(0)
    v_cmp_eq_u32 vcc, 1, v43
    s_nop 4
    s_andn2_b32 s71, -1, vcc_lo
    s_cbranch_scc0 POLLD0
    s_add_u32 s81, s81, 1
    s_cmp_gt_u32 s81, 0x10000
    s_cbranch_scc1 POLLD0
    s_sleep 1
    s_branch POLL0
POLLD0:
    s_branch CKDN
CKSW:
    s_mov_b32 s81, 0
POLL1:
    buffer_load_dword v47, v45, s[52:55], 0 offen sc1
    s_waitcnt vmcnt(0)
    v_cmp_eq_u32 vcc, s38, v47
    s_nop 4
    s_andn2_b32 s71, -1, vcc_lo
    s_cbranch_scc0 POLLD1
    s_add_u32 s81, s81, 1
    s_cmp_gt_u32 s81, 0x10000
    s_cbranch_scc1 POLLD1
    s_sleep 1
    s_branch POLL1
POLLD1:
    s_branch CKDW
CKSG:
    s_mov_b32 s81, 0
POLL2:
    buffer_load_dword v47, v45, s[52:55], 0 offen offset:1024 sc1
    s_waitcnt vmcnt(0)
    v_cmp_eq_u32 vcc, s38, v47
    s_nop 4
    s_andn2_b32 s71, -1, vcc_lo
    s_cbranch_scc0 POLLD2
    s_add_u32 s81, s81, 1
    s_cmp_gt_u32 s81, 0x10000
    s_cbranch_scc1 POLLD2
    s_sleep 1
    s_branch POLL2
POLLD2:
    s_branch CKDG
K1_LX1:
    v_mov_b32 v28, v64
    v_mov_b32 v29, v66
    s_branch K1_LBD
K1_LX2:
    v_mov_b32 v28, v68
    v_mov_b32 v29, v70
    s_branch K1_LBD
K1_LX3:
    v_mov_b32 v28, v72
    v_mov_b32 v29, v74
    s_branch K1_LBD
K1_LX4:
    v_mov_b32 v28, v76
    v_mov_b32 v29, v78
    s_branch K1_LBD
K1_LX5:
    v_mov_b32 v28, v80
    v_mov_b32 v29, v82
    s_branch K1_LBD
K1_LX6:
    v_mov_b32 v28, v84
    v_mov_b32 v29, v86
    s_branch K1_LBD
K1_LX7:
    v_mov_b32 v28, v88
    v_mov_b32 v29, v90
    s_branch K1_LBD
K1_LX8:
    v_mov_b32 v28, v92
    v_mov_b32 v29, v94
    s_branch K1_LBD
K1_LX9:
    v_mov_b32 v28, v128
    v_mov_b32 v29, v130
    s_branch K1_LBD
K1_LX10:
    v_mov_b32 v28, v132
    v_mov_b32 v29, v134
    s_branch K1_LBD
K1_LX11:
    v_mov_b32 v28, v136
    v_mov_b32 v29, v138
    s_branch K1_LBD
K1_LX12:
    v_mov_b32 v28, v140
    v_mov_b32 v29, v142
    s_branch K1_LBD
K1_LX13:
    v_mov_b32 v28, v144
    v_mov_b32 v29, v146
    s_branch K1_LBD
K1_LX14:
    v_mov_b32 v28, v148
    v_mov_b32 v29, v150
    s_branch K1_LBD
K1_PLAIN:
    s_waitcnt vmcnt(9)
    s_barrier
    ds_read_b64_tr_b16 v[56:57], v18 offset:0
    ds_read_b64_tr_b16 v[58:59], v18 offset:1024
    ds_read_b128 v[48:51], v6 offset:0
    ds_read_b128 v[52:55], v10 offset:0
    ds_read_b64_tr_b16 v[60:61], v18 offset:8192
    ds_read_b64_tr_b16 v[62:63], v18 offset:9216
    s_waitcnt vmcnt(7) lgkmcnt(0)
    s_barrier
    v_mfma_f32_32x32x16_bf16 v[96:111], v[56:59], v[48:51], 0
    ds_read_b64_tr_b16 v[80:81], v18 offset:4096
    ds_read_b64_tr_b16 v[82:83], v18 offset:5120
    v_mfma_f32_32x32x16_bf16 v[112:127], v[56:59], v[52:55], 0
    ds_read_b128 v[72:75], v7 offset:0
    ds_read_b128 v[76:79], v11 offset:0
    v_mfma_f32_32x32x16_bf16 v[128:143], v[60:63], v[48:51], 0
    ds_read_b64_tr_b16 v[84:85], v18 offset:12288
    ds_read_b64_tr_b16 v[86:87], v18 offset:13312
    v_mfma_f32_32x32x16_bf16 v[144:159], v[60:63], v[52:55], 0
    s_mov_b32 s71, 256
    s_add_u32 m0, s68, 49152
    s_nop 0
    buffer_load_dwordx4 v2, s[40:43], s71 offen lds
    s_add_u32 m0, s68, 50176
    s_nop 0
    buffer_load_dwordx4 v3, s[40:43], s71 offen lds
    s_add_u32 m0, s69, 65536
    s_nop 0
    buffer_load_dwordx4 v4, s[44:47], s71 offen lds
    s_mov_b32 s71, 458752
    s_add_u32 m0, s68, 139264
    s_nop 0
    buffer_load_dwordx4 v5, s[48:51], s71 offen lds
    s_mov_b32 s71, 473088
    s_add_u32 m0, s68, 140288
    s_nop 0
    buffer_load_dwordx4 v5, s[48:51], s71 offen lds
    s_waitcnt lgkmcnt(0)
    v_mfma_f32_32x32x16_bf16 v[96:111], v[80:83], v[72:75], v[96:111]
    ds_read_b64_tr_b16 v[56:57], v18 offset:16384
    ds_read_b64_tr_b16 v[58:59], v18 offset:17408
    v_mfma_f32_32x32x16_bf16 v[112:127], v[80:83], v[76:79], v[112:127]
    ds_read_b128 v[48:51], v8 offset:0
    ds_read_b128 v[52:55], v12 offset:0
    v_mfma_f32_32x32x16_bf16 v[128:143], v[84:87], v[72:75], v[128:143]
    ds_read_b64_tr_b16 v[60:61], v18 offset:24576
    ds_read_b64_tr_b16 v[62:63], v18 offset:25600
    v_mfma_f32_32x32x16_bf16 v[144:159], v[84:87], v[76:79], v[144:159]
    s_waitcnt vmcnt(7) lgkmcnt(0)
    s_barrier
    v_mfma_f32_32x32x16_bf16 v[96:111], v[56:59], v[48:51], v[96:111]
    ds_read_b64_tr_b16 v[80:81], v18 offset:20480
    ds_read_b64_tr_b16 v[82:83], v18 offset:21504
    v_mfma_f32_32x32x16_bf16 v[112:127], v[56:59], v[52:55], v[112:127]
    ds_read_b128 v[72:75], v9 offset:0
    ds_read_b128 v[76:79], v13 offset:0
    v_mfma_f32_32x32x16_bf16 v[128:143], v[60:63], v[48:51], v[128:143]
    ds_read_b64_tr_b16 v[84:85], v18 offset:28672
    ds_read_b64_tr_b16 v[86:87], v18 offset:29696
    v_mfma_f32_32x32x16_bf16 v[144:159], v[60:63], v[52:55], v[144:159]
    buffer_load_dwordx2 v[42:43], v44, s[56:59], 0 offen sc1
    s_mov_b32 s71, 573440
    s_add_u32 m0, s68, 73728
    s_nop 0
    buffer_load_dwordx4 v5, s[48:51], s71 offen lds
    s_mov_b32 s71, 587776
    s_add_u32 m0, s68, 74752
    s_nop 0
    buffer_load_dwordx4 v5, s[48:51], s71 offen lds
    s_waitcnt lgkmcnt(0)
    v_mfma_f32_32x32x16_bf16 v[96:111], v[80:83], v[72:75], v[96:111]
    ds_read_b64_tr_b16 v[56:57], v18 offset:32768
    ds_read_b64_tr_b16 v[58:59], v18 offset:33792
    v_mfma_f32_32x32x16_bf16 v[112:127], v[80:83], v[76:79], v[112:127]
    ds_read_b128 v[48:51], v6 offset:24576
    ds_read_b128 v[52:55], v10 offset:24576
    v_mfma_f32_32x32x16_bf16 v[128:143], v[84:87], v[72:75], v[128:143]
    ds_read_b64_tr_b16 v[60:61], v18 offset:40960
    ds_read_b64_tr_b16 v[62:63], v18 offset:41984
    v_mfma_f32_32x32x16_bf16 v[144:159], v[84:87], v[76:79], v[144:159]
    s_waitcnt vmcnt(8) lgkmcnt(0)
    s_barrier
    v_mfma_f32_32x32x16_bf16 v[96:111], v[56:59], v[48:51], v[96:111]
    ds_read_b64_tr_b16 v[80:81], v18 offset:36864
    ds_read_b64_tr_b16 v[82:83], v18 offset:37888
    v_mfma_f32_32x32x16_bf16 v[112:127], v[56:59], v[52:55], v[112:127]
    ds_read_b128 v[72:75], v7 offset:24576
    ds_read_b128 v[76:79], v11 offset:24576
    v_mfma_f32_32x32x16_bf16 v[128:143], v[60:63], v[48:51], v[128:143]
    ds_read_b64_tr_b16 v[84:85], v18 offset:45056
    ds_read_b64_tr_b16 v[86:87], v18 offset:46080
    v_mfma_f32_32x32x16_bf16 v[144:159], v[60:63], v[52:55], v[144:159]
    s_mov_b32 s71, 384
    s_add_u32 m0, s68, 0
    s_nop 0
    buffer_load_dwordx4 v2, s[40:43], s71 offen lds
    s_add_u32 m0, s68, 1024
    s_nop 0
    buffer_load_dwordx4 v3, s[40:43], s71 offen lds
    s_add_u32 m0, s69, 16384
    s_nop 0
    buffer_load_dwordx4 v4, s[44:47], s71 offen lds
    s_mov_b32 s71, 688128
    s_add_u32 m0, s68, 90112
    s_nop 0
    buffer_load_dwordx4 v5, s[48:51], s71 offen lds
    s_mov_b32 s71, 702464
    s_add_u32 m0, s68, 91136
    s_nop 0
    buffer_load_dwordx4 v5, s[48:51], s71 offen lds
    s_waitcnt lgkmcnt(0)
    v_mfma_f32_32x32x16_bf16 v[96:111], v[80:83], v[72:75], v[96:111]
    ds_read_b64_tr_b16 v[56:57], v19 offset:0
    ds_read_b64_tr_b16 v[58:59], v19 offset:1024
    v_mfma_f32_32x32x16_bf16 v[112:127], v[80:83], v[76:79], v[112:127]
    ds_read_b128 v[48:51], v8 offset:24576
    ds_read_b128 v[52:55], v12 offset:24576
    v_mfma_f32_32x32x16_bf16 v[128:143], v[84:87], v[72:75], v[128:143]
    ds_read_b64_tr_b16 v[60:61], v19 offset:8192
    ds_read_b64_tr_b16 v[62:63], v19 offset:9216
    v_mfma_f32_32x32x16_bf16 v[144:159], v[84:87], v[76:79], v[144:159]
    s_waitcnt vmcnt(8) lgkmcnt(0)
    s_barrier
    v_mfma_f32_32x32x16_bf16 v[96:111], v[56:59], v[48:51], v[96:111]
    ds_read_b64_tr_b16 v[80:81], v19 offset:4096
    ds_read_b64_tr_b16 v[82:83], v19 offset:5120
    v_mfma_f32_32x32x16_bf16 v[112:127], v[56:59], v[52:55], v[112:127]
    ds_read_b128 v[72:75], v9 offset:24576
    ds_read_b128 v[76:79], v13 offset:24576
    v_mfma_f32_32x32x16_bf16 v[128:143], v[60:63], v[48:51], v[128:143]
    ds_read_b64_tr_b16 v[84:85], v19 offset:12288
    ds_read_b64_tr_b16 v[86:87], v19 offset:13312
    v_mfma_f32_32x32x16_bf16 v[144:159], v[60:63], v[52:55], v[144:159]
    s_mov_b32 s71, 802816
    s_add_u32 m0, s68, 106496
    s_nop 0
    buffer_load_dwordx4 v5, s[48:51], s71 offen lds
    s_mov_b32 s71, 817152
    s_add_u32 m0, s68, 107520
    s_nop 0
    buffer_load_dwordx4 v5, s[48:51], s71 offen lds
    s_waitcnt lgkmcnt(0)
    v_mfma_f32_32x32x16_bf16 v[96:111], v[80:83], v[72:75], v[96:111]
    ds_read_b64_tr_b16 v[56:57], v19 offset:16384
    ds_read_b64_tr_b16 v[58:59], v19 offset:17408
    v_mfma_f32_32x32x16_bf16 v[112:127], v[80:83], v[76:79], v[112:127]
    ds_read_b128 v[48:51], v6 offset:49152
    ds_read_b128 v[52:55], v10 offset:49152
    v_mfma_f32_32x32x16_bf16 v[128:143], v[84:87], v[72:75], v[128:143]
    ds_read_b64_tr_b16 v[60:61], v19 offset:24576
    ds_read_b64_tr_b16 v[62:63], v19 offset:25600
    v_mfma_f32_32x32x16_bf16 v[144:159], v[84:87], v[76:79], v[144:159]
    s_waitcnt vmcnt(7) lgkmcnt(0)
    s_barrier
    s_cmp_lg_u32 s64, 4
    s_cbranch_scc1 CKRN
    v_cmp_eq_u32 vcc, 1, v43
    s_nop 4
    s_cmp_eq_u32 vcc_lo, -1
    s_cbranch_scc0 CKSN
CKDN:
    v_readfirstlane_b32 s38, v42
    v_mov_b32 v44, 157696
    v_mov_b32 v43, 0
    ds_write_b64 v44, v[42:43]
CKRN:
    v_mfma_f32_32x32x16_bf16 v[96:111], v[56:59], v[48:51], v[96:111]
    ds_read_b64_tr_b16 v[80:81], v19 offset:20480
    ds_read_b64_tr_b16 v[82:83], v19 offset:21504
    v_mfma_f32_32x32x16_bf16 v[112:127], v[56:59], v[52:55], v[112:127]
    ds_read_b128 v[72:75], v7 offset:49152
    ds_read_b128 v[76:79], v11 offset:49152
    v_mfma_f32_32x32x16_bf16 v[128:143], v[60:63], v[48:51], v[128:143]
    ds_read_b64_tr_b16 v[84:85], v19 offset:28672
    ds_read_b64_tr_b16 v[86:87], v19 offset:29696
    v_mfma_f32_32x32x16_bf16 v[144:159], v[60:63], v[52:55], v[144:159]
    s_mov_b32 s71, 512
    s_add_u32 m0, s68, 24576
    s_nop 0
    buffer_load_dwordx4 v2, s[40:43], s71 offen lds
    s_add_u32 m0, s68, 25600
    s_nop 0
    buffer_load_dwordx4 v3, s[40:43], s71 offen lds
    s_add_u32 m0, s69, 40960
    s_nop 0
    buffer_load_dwordx4 v4, s[44:47], s71 offen lds
    s_mov_b32 s71, 917504
    s_add_u32 m0, s68, 122880
    s_nop 0
    buffer_load_dwordx4 v5, s[48:51], s71 offen lds
    s_mov_b32 s71, 931840
    s_add_u32 m0, s68, 123904
    s_nop 0
    buffer_load_dwordx4 v5, s[48:51], s71 offen lds
    s_waitcnt lgkmcnt(0)
    v_mfma_f32_32x32x16_bf16 v[96:111], v[80:83], v[72:75], v[96:111]
    ds_read_b64_tr_b16 v[56:57], v18 offset:0
    ds_read_b64_tr_b16 v[58:59], v18 offset:1024
    v_mfma_f32_32x32x16_bf16 v[112:127], v[80:83], v[76:79], v[112:127]
    ds_read_b128 v[48:51], v8 offset:49152
    ds_read_b128 v[52:55], v12 offset:49152
    v_mfma_f32_32x32x16_bf16 v[128:143], v[84:87], v[72:75], v[128:143]
    ds_read_b64_tr_b16 v[60:61], v18 offset:8192
    ds_read_b64_tr_b16 v[62:63], v18 offset:9216
    v_mfma_f32_32x32x16_bf16 v[144:159], v[84:87], v[76:79], v[144:159]
    s_waitcnt vmcnt(7) lgkmcnt(0)
    s_barrier
    v_mfma_f32_32x32x16_bf16 v[96:111], v[56:59], v[48:51], v[96:111]
    ds_read_b64_tr_b16 v[80:81], v18 offset:4096
    ds_read_b64_tr_b16 v[82:83], v18 offset:5120
    v_mfma_f32_32x32x16_bf16 v[112:127], v[56:59], v[52:55], v[112:127]
    ds_read_b128 v[72:75], v9 offset:49152
    ds_read_b128 v[76:79], v13 offset:49152
    v_mfma_f32_32x32x16_bf16 v[128:143], v[60:63], v[48:51], v[128:143]
    ds_read_b64_tr_b16 v[84:85], v18 offset:12288
    ds_read_b64_tr_b16 v[86:87], v18 offset:13312
    v_mfma_f32_32x32x16_bf16 v[144:159], v[60:63], v[52:55], v[144:159]
    s_mov_b32 s71, 1032192
    s_add_u32 m0, s68, 139264
    s_nop 0
    buffer_load_dwordx4 v5, s[48:51], s71 offen lds
    s_mov_b32 s71, 1046528
    s_add_u32 m0, s68, 140288
    s_nop 0
    buffer_load_dwordx4 v5, s[48:51], s71 offen lds
    s_waitcnt lgkmcnt(0)
    v_mfma_f32_32x32x16_bf16 v[96:111], v[80:83], v[72:75], v[96:111]
    ds_read_b64_tr_b16 v[56:57], v18 offset:16384
    ds_read_b64_tr_b16 v[58:59], v18 offset:17408
    v_mfma_f32_32x32x16_bf16 v[112:127], v[80:83], v[76:79], v[112:127]
    ds_read_b128 v[48:51], v6 offset:0
    ds_read_b128 v[52:55], v10 offset:0
    v_mfma_f32_32x32x16_bf16 v[128:143], v[84:87], v[72:75], v[128:143]
    ds_read_b64_tr_b16 v[60:61], v18 offset:24576
    ds_read_b64_tr_b16 v[62:63], v18 offset:25600
    v_mfma_f32_32x32x16_bf16 v[144:159], v[84:87], v[76:79], v[144:159]
    s_waitcnt vmcnt(7) lgkmcnt(0)
    s_barrier
    v_mfma_f32_32x32x16_bf16 v[96:111], v[56:59], v[48:51], v[96:111]
    ds_read_b64_tr_b16 v[80:81], v18 offset:20480
    ds_read_b64_tr_b16 v[82:83], v18 offset:21504
    v_mfma_f32_32x32x16_bf16 v[112:127], v[56:59], v[52:55], v[112:127]
    ds_read_b128 v[72:75], v7 offset:0
    ds_read_b128 v[76:79], v11 offset:0
    v_mfma_f32_32x32x16_bf16 v[128:143], v[60:63], v[48:51], v[128:143]
    ds_read_b64_tr_b16 v[84:85], v18 offset:28672
    ds_read_b64_tr_b16 v[86:87], v18 offset:29696
    v_mfma_f32_32x32x16_bf16 v[144:159], v[60:63], v[52:55], v[144:159]
    s_mov_b32 s71, 640
    s_add_u32 m0, s68, 49152
    s_nop 0
    buffer_load_dwordx4 v2, s[40:43], s71 offen lds
    s_add_u32 m0, s68, 50176
    s_nop 0
    buffer_load_dwordx4 v3, s[40:43], s71 offen lds
    s_add_u32 m0, s69, 65536
    s_nop 0
    buffer_load_dwordx4 v4, s[44:47], s71 offen lds
    s_mov_b32 s71, 1146880
    s_add_u32 m0, s68, 73728
    s_nop 0
    buffer_load_dwordx4 v5, s[48:51], s71 offen lds
    s_mov_b32 s71, 1161216
    s_add_u32 m0, s68, 74752
    s_nop 0
    buffer_load_dwordx4 v5, s[48:51], s71 offen lds
    s_waitcnt lgkmcnt(0)
    v_mfma_f32_32x32x16_bf16 v[96:111], v[80:83], v[72:75], v[96:111]
    ds_read_b64_tr_b16 v[56:57], v18 offset:32768
    ds_read_b64_tr_b16 v[58:59], v18 offset:33792
    v_mfma_f32_32x32x16_bf16 v[112:127], v[80:83], v[76:79], v[112:127]
    ds_read_b128 v[48:51], v8 offset:0
    ds_read_b128 v[52:55], v12 offset:0
    v_mfma_f32_32x32x16_bf16 v[128:143], v[84:87], v[72:75], v[128:143]
    ds_read_b64_tr_b16 v[60:61], v18 offset:40960
    ds_read_b64_tr_b16 v[62:63], v18 offset:41984
    v_mfma_f32_32x32x16_bf16 v[144:159], v[84:87], v[76:79], v[144:159]
    s_waitcnt vmcnt(7) lgkmcnt(0)
    s_barrier
    v_mfma_f32_32x32x16_bf16 v[96:111], v[56:59], v[48:51], v[96:111]
    ds_read_b64_tr_b16 v[80:81], v18 offset:36864
    ds_read_b64_tr_b16 v[82:83], v18 offset:37888
    v_mfma_f32_32x32x16_bf16 v[112:127], v[56:59], v[52:55], v[112:127]
    ds_read_b128 v[72:75], v9 offset:0
    ds_read_b128 v[76:79], v13 offset:0
    v_mfma_f32_32x32x16_bf16 v[128:143], v[60:63], v[48:51], v[128:143]
    ds_read_b64_tr_b16 v[84:85], v18 offset:45056
    ds_read_b64_tr_b16 v[86:87], v18 offset:46080
    v_mfma_f32_32x32x16_bf16 v[144:159], v[60:63], v[52:55], v[144:159]
    buffer_load_dword v47, v45, s[52:55], 0 offen sc1
    s_mov_b32 s71, 1261568
    s_add_u32 m0, s68, 90112
    s_nop 0
    buffer_load_dwordx4 v5, s[48:51], s71 offen lds
    s_mov_b32 s71, 1275904
    s_add_u32 m0, s68, 91136
    s_nop 0
    buffer_load_dwordx4 v5, s[48:51], s71 offen lds
    s_waitcnt lgkmcnt(0)
    v_mfma_f32_32x32x16_bf16 v[96:111], v[80:83], v[72:75], v[96:111]
    ds_read_b64_tr_b16 v[56:57], v19 offset:0
    ds_read_b64_tr_b16 v[58:59], v19 offset:1024
    v_mfma_f32_32x32x16_bf16 v[112:127], v[80:83], v[76:79], v[112:127]
    ds_read_b128 v[48:51], v6 offset:24576
    ds_read_b128 v[52:55], v10 offset:24576
    v_mfma_f32_32x32x16_bf16 v[128:143], v[84:87], v[72:75], v[128:143]
    ds_read_b64_tr_b16 v[60:61], v19 offset:8192
    ds_read_b64_tr_b16 v[62:63], v19 offset:9216
    v_mfma_f32_32x32x16_bf16 v[144:159], v[84:87], v[76:79], v[144:159]
    s_waitcnt vmcnt(8) lgkmcnt(0)
    s_barrier
    v_mfma_f32_32x32x16_bf16 v[96:111], v[56:59], v[48:51], v[96:111]
    ds_read_b64_tr_b16 v[80:81], v19 offset:4096
    ds_read_b64_tr_b16 v[82:83], v19 offset:5120
    v_mfma_f32_32x32x16_bf16 v[112:127], v[56:59], v[52:55], v[112:127]
    ds_read_b128 v[72:75], v7 offset:24576
    ds_read_b128 v[76:79], v11 offset:24576
    v_mfma_f32_32x32x16_bf16 v[128:143], v[60:63], v[48:51], v[128:143]
    ds_read_b64_tr_b16 v[84:85], v19 offset:12288
    ds_read_b64_tr_b16 v[86:87], v19 offset:13312
    v_mfma_f32_32x32x16_bf16 v[144:159], v[60:63], v[52:55], v[144:159]
    s_mov_b32 s71, 768
    s_add_u32 m0, s68, 0
    s_nop 0
    buffer_load_dwordx4 v2, s[40:43], s71 offen lds
    s_add_u32 m0, s68, 1024
    s_nop 0
    buffer_load_dwordx4 v3, s[40:43], s71 offen lds
    s_add_u32 m0, s69, 16384
    s_nop 0
    buffer_load_dwordx4 v4, s[44:47], s71 offen lds
    s_mov_b32 s71, 1376256
    s_add_u32 m0, s68, 106496
    s_nop 0
    buffer_load_dwordx4 v5, s[48:51], s71 offen lds
    s_mov_b32 s71, 1390592
    s_add_u32 m0, s68, 107520
    s_nop 0
    buffer_load_dwordx4 v5, s[48:51], s71 offen lds
    s_waitcnt lgkmcnt(0)
    v_mfma_f32_32x32x16_bf16 v[96:111], v[80:83], v[72:75], v[96:111]
    ds_read_b64_tr_b16 v[56:57], v19 offset:16384
    ds_read_b64_tr_b16 v[58:59], v19 offset:17408
    v_mfma_f32_32x32x16_bf16 v[112:127], v[80:83], v[76:79], v[112:127]
    ds_read_b128 v[48:51], v8 offset:24576
    ds_read_b128 v[52:55], v12 offset:24576
    v_mfma_f32_32x32x16_bf16 v[128:143], v[84:87], v[72:75], v[128:143]
    ds_read_b64_tr_b16 v[60:61], v19 offset:24576
    ds_read_b64_tr_b16 v[62:63], v19 offset:25600
    v_mfma_f32_32x32x16_bf16 v[144:159], v[84:87], v[76:79], v[144:159]
    s_waitcnt vmcnt(8) lgkmcnt(0)
    s_barrier
    v_mfma_f32_32x32x16_bf16 v[96:111], v[56:59], v[48:51], v[96:111]
    ds_read_b64_tr_b16 v[80:81], v19 offset:20480
    ds_read_b64_tr_b16 v[82:83], v19 offset:21504
    v_mfma_f32_32x32x16_bf16 v[112:127], v[56:59], v[52:55], v[112:127]
    ds_read_b128 v[72:75], v9 offset:24576
    ds_read_b128 v[76:79], v13 offset:24576
    v_mfma_f32_32x32x16_bf16 v[128:143], v[60:63], v[48:51], v[128:143]
    ds_read_b64_tr_b16 v[84:85], v19 offset:28672
    ds_read_b64_tr_b16 v[86:87], v19 offset:29696
    v_mfma_f32_32x32x16_bf16 v[144:159], v[60:63], v[52:55], v[144:159]
    s_mov_b32 s71, 1490944
    s_add_u32 m0, s68, 122880
    s_nop 0
    buffer_load_dwordx4 v5, s[48:51], s71 offen lds
    s_mov_b32 s71, 1505280
    s_add_u32 m0, s68, 123904
    s_nop 0
    buffer_load_dwordx4 v5, s[48:51], s71 offen lds
    s_waitcnt lgkmcnt(0)
    v_mfma_f32_32x32x16_bf16 v[96:111], v[80:83], v[72:75], v[96:111]
    ds_read_b64_tr_b16 v[56:57], v18 offset:0
    ds_read_b64_tr_b16 v[58:59], v18 offset:1024
    v_mfma_f32_32x32x16_bf16 v[112:127], v[80:83], v[76:79], v[112:127]
    ds_read_b128 v[48:51], v6 offset:49152
    ds_read_b128 v[52:55], v10 offset:49152
    v_mfma_f32_32x32x16_bf16 v[128:143], v[84:87], v[72:75], v[128:143]
    ds_read_b64_tr_b16 v[60:61], v18 offset:8192
    ds_read_b64_tr_b16 v[62:63], v18 offset:9216
    v_mfma_f32_32x32x16_bf16 v[144:159], v[84:87], v[76:79], v[144:159]
    s_waitcnt vmcnt(7) lgkmcnt(0)
    s_cmp_lg_u32 s64, 4
    s_cbranch_scc1 CKRW
    v_cmp_eq_u32 vcc, s38, v47
    s_nop 4
    s_cmp_eq_u32 vcc_lo, -1
    s_cbranch_scc0 CKSW
CKDW:
CKRW:
    s_barrier
    v_mfma_f32_32x32x16_bf16 v[96:111], v[56:59], v[48:51], v[96:111]
    ds_read_b64_tr_b16 v[80:81], v18 offset:4096
    ds_read_b64_tr_b16 v[82:83], v18 offset:5120
    v_mfma_f32_32x32x16_bf16 v[112:127], v[56:59], v[52:55], v[112:127]
    ds_read_b128 v[72:75], v7 offset:49152
    ds_read_b128 v[76:79], v11 offset:49152
    v_mfma_f32_32x32x16_bf16 v[128:143], v[60:63], v[48:51], v[128:143]
    ds_read_b64_tr_b16 v[84:85], v18 offset:12288
    ds_read_b64_tr_b16 v[86:87], v18 offset:13312
    v_mfma_f32_32x32x16_bf16 v[144:159], v[60:63], v[52:55], v[144:159]
    s_add_u32 s93, s82, s4
    buffer_load_dwordx4 v[192:195], v46, s[52:55], s93 offen
    s_add_u32 s93, s83, s4
    buffer_load_dwordx4 v[196:199], v46, s[52:55], s93 offen
    s_add_u32 s93, s82, s5
    buffer_load_dwordx4 v[200:203], v46, s[52:55], s93 offen
    s_waitcnt lgkmcnt(0)
    v_mfma_f32_32x32x16_bf16 v[96:111], v[80:83], v[72:75], v[96:111]
    ds_read_b64_tr_b16 v[56:57], v18 offset:16384
    ds_read_b64_tr_b16 v[58:59], v18 offset:17408
    v_mfma_f32_32x32x16_bf16 v[112:127], v[80:83], v[76:79], v[112:127]
    ds_read_b128 v[48:51], v8 offset:49152
    ds_read_b128 v[52:55], v12 offset:49152
    v_mfma_f32_32x32x16_bf16 v[128:143], v[84:87], v[72:75], v[128:143]
    ds_read_b64_tr_b16 v[60:61], v18 offset:24576
    ds_read_b64_tr_b16 v[62:63], v18 offset:25600
    v_mfma_f32_32x32x16_bf16 v[144:159], v[84:87], v[76:79], v[144:159]
    s_add_u32 s93, s83, s5
    buffer_load_dwordx4 v[204:207], v46, s[52:55], s93 offen
    s_add_u32 s93, s82, s6
    buffer_load_dwordx4 v[208:211], v46, s[52:55], s93 offen
    s_add_u32 s93, s83, s6
    buffer_load_dwordx4 v[212:215], v46, s[52:55], s93 offen
    s_waitcnt vmcnt(8) lgkmcnt(0)
    s_barrier
    v_mfma_f32_32x32x16_bf16 v[96:111], v[56:59], v[48:51], v[96:111]
    ds_read_b64_tr_b16 v[80:81], v18 offset:20480
    ds_read_b64_tr_b16 v[82:83], v18 offset:21504
    v_mfma_f32_32x32x16_bf16 v[112:127], v[56:59], v[52:55], v[112:127]
    ds_read_b128 v[72:75], v9 offset:49152
    ds_read_b128 v[76:79], v13 offset:49152
    v_mfma_f32_32x32x16_bf16 v[128:143], v[60:63], v[48:51], v[128:143]
    ds_read_b64_tr_b16 v[84:85], v18 offset:28672
    ds_read_b64_tr_b16 v[86:87], v18 offset:29696
    v_mfma_f32_32x32x16_bf16 v[144:159], v[60:63], v[52:55], v[144:159]
    buffer_load_dword v47, v45, s[52:55], 0 offen offset:1024 sc1
    s_add_u32 s93, s82, s7
    buffer_load_dwordx4 v[216:219], v46, s[52:55], s93 offen
    s_add_u32 s93, s83, s7
    buffer_load_dwordx4 v[220:223], v46, s[52:55], s93 offen
    s_add_u32 s93, s82, s8
    buffer_load_dwordx4 v[224:227], v46, s[52:55], s93 offen
    s_waitcnt lgkmcnt(0)
    v_mfma_f32_32x32x16_bf16 v[96:111], v[80:83], v[72:75], v[96:111]
    ds_read_b64_tr_b16 v[56:57], v18 offset:32768
    ds_read_b64_tr_b16 v[58:59], v18 offset:33792
    v_mfma_f32_32x32x16_bf16 v[112:127], v[80:83], v[76:79], v[112:127]
    ds_read_b128 v[48:51], v6 offset:0
    ds_read_b128 v[52:55], v10 offset:0
    v_mfma_f32_32x32x16_bf16 v[128:143], v[84:87], v[72:75], v[128:143]
    ds_read_b64_tr_b16 v[60:61], v18 offset:40960
    ds_read_b64_tr_b16 v[62:63], v18 offset:41984
    v_mfma_f32_32x32x16_bf16 v[144:159], v[84:87], v[76:79], v[144:159]
    s_add_u32 s93, s83, s8
    buffer_load_dwordx4 v[228:231], v46, s[52:55], s93 offen
    s_add_u32 s93, s82, s9
    buffer_load_dwordx4 v[232:235], v46, s[52:55], s93 offen
    s_add_u32 s93, s83, s9
    buffer_load_dwordx4 v[236:239], v46, s[52:55], s93 offen
    s_waitcnt vmcnt(13) lgkmcnt(0)
    s_barrier
    v_mfma_f32_32x32x16_bf16 v[96:111], v[56:59], v[48:51], v[96:111]
    ds_read_b64_tr_b16 v[80:81], v18 offset:36864
    ds_read_b64_tr_b16 v[82:83], v18 offset:37888
    v_mfma_f32_32x32x16_bf16 v[112:127], v[56:59], v[52:55], v[112:127]
    ds_read_b128 v[72:75], v7 offset:0
    ds_read_b128 v[76:79], v11 offset:0
    v_mfma_f32_32x32x16_bf16 v[128:143], v[60:63], v[48:51], v[128:143]
    ds_read_b64_tr_b16 v[84:85], v18 offset:45056
    ds_read_b64_tr_b16 v[86:87], v18 offset:46080
    v_mfma_f32_32x32x16_bf16 v[144:159], v[60:63], v[52:55], v[144:159]
    s_add_u32 s93, s82, s10
    buffer_load_dwordx4 v[240:243], v46, s[52:55], s93 offen
    s_add_u32 s93, s83, s10
    buffer_load_dwordx4 v[244:247], v46, s[52:55], s93 offen
    s_add_u32 s93, s82, s11
    buffer_load_dwordx4 v[248:251], v46, s[52:55], s93 offen
    s_waitcnt lgkmcnt(0)
    v_mfma_f32_32x32x16_bf16 v[96:111], v[80:83], v[72:75], v[96:111]
    ds_read_b64_tr_b16 v[56:57], v19 offset:0
    ds_read_b64_tr_b16 v[58:59], v19 offset:1024
    v_mfma_f32_32x32x16_bf16 v[112:127], v[80:83], v[76:79], v[112:127]
    ds_read_b128 v[48:51], v8 offset:0
    ds_read_b128 v[52:55], v12 offset:0
    v_mfma_f32_32x32x16_bf16 v[128:143], v[84:87], v[72:75], v[128:143]
    ds_read_b64_tr_b16 v[60:61], v19 offset:8192
    ds_read_b64_tr_b16 v[62:63], v19 offset:9216
    v_mfma_f32_32x32x16_bf16 v[144:159], v[84:87], v[76:79], v[144:159]
    s_add_u32 s93, s83, s11
    buffer_load_dwordx4 v[252:255], v46, s[52:55], s93 offen
    s_add_u32 s93, s82, s12
    buffer_load_dwordx4 v[160:163], v46, s[52:55], s93 offen
    s_add_u32 s93, s83, s12
    buffer_load_dwordx4 v[164:167], v46, s[52:55], s93 offen
    s_waitcnt lgkmcnt(0)
    v_mfma_f32_32x32x16_bf16 v[96:111], v[56:59], v[48:51], v[96:111]
    ds_read_b64_tr_b16 v[80:81], v19 offset:4096
    ds_read_b64_tr_b16 v[82:83], v19 offset:5120
    v_mfma_f32_32x32x16_bf16 v[112:127], v[56:59], v[52:55], v[112:127]
    ds_read_b128 v[72:75], v9 offset:0
    ds_read_b128 v[76:79], v13 offset:0
    v_mfma_f32_32x32x16_bf16 v[128:143], v[60:63], v[48:51], v[128:143]
    ds_read_b64_tr_b16 v[84:85], v19 offset:12288
    ds_read_b64_tr_b16 v[86:87], v19 offset:13312
    v_mfma_f32_32x32x16_bf16 v[144:159], v[60:63], v[52:55], v[144:159]
    s_add_u32 s93, s82, s13
    buffer_load_dwordx4 v[168:171], v46, s[52:55], s93 offen
    s_add_u32 s93, s83, s13
    buffer_load_dwordx4 v[172:175], v46, s[52:55], s93 offen
    s_add_u32 s93, s82, s14
    buffer_load_dwordx4 v[176:179], v46, s[52:55], s93 offen
    s_waitcnt lgkmcnt(0)
    v_mfma_f32_32x32x16_bf16 v[96:111], v[80:83], v[72:75], v[96:111]
    v_mfma_f32_32x32x16_bf16 v[112:127], v[80:83], v[76:79], v[112:127]
    v_mfma_f32_32x32x16_bf16 v[128:143], v[84:87], v[72:75], v[128:143]
    v_mfma_f32_32x32x16_bf16 v[144:159], v[84:87], v[76:79], v[144:159]
    s_add_u32 s93, s83, s14
    buffer_load_dwordx4 v[180:183], v46, s[52:55], s93 offen
    s_add_u32 s93, s82, s15
    buffer_load_dwordx4 v[184:187], v46, s[52:55], s93 offen
    s_add_u32 s93, s83, s15
    buffer_load_dwordx4 v[188:191], v46, s[52:55], s93 offen
    s_mov_b32 s30, 1.0
    s_mov_b32 s72, 0xbdd2d3e8
    v_mov_b32 v36, 0xc0135761
    v_lshlrev_b32 v37, 4, v1
    s_lshl_b32 s75, s65, 2
    s_add_u32 s73, s75, s67
    s_xor_b32 s74, s73, 1
    s_mul_i32 s73, s73, 172032
    s_mul_i32 s74, s74, 172032
    s_lshl_b32 s75, s66, 13
    s_lshr_b32 s76, s64, 1
    s_lshl_b32 s76, s76, 11
    s_add_u32 s75, s75, s76
    s_add_u32 s76, s73, 114688
    s_add_u32 s73, s73, s75
    s_add_u32 s74, s74, s75
    s_lshl_b32 s75, s66, 12
    s_add_u32 s76, s76, s75
    s_add_u32 s93, s82, s16
    buffer_load_dwordx4 v[72:75], v46, s[52:55], s93 offen
    s_add_u32 s93, s83, s16
    buffer_load_dwordx4 v[76:79], v46, s[52:55], s93 offen
    s_add_u32 s93, s82, s17
    buffer_load_dwordx4 v[80:83], v46, s[52:55], s93 offen
    s_add_u32 s93, s83, s17
    buffer_load_dwordx4 v[84:87], v46, s[52:55], s93 offen
    s_add_u32 s93, s84, s18
    buffer_load_dwordx4 v[88:91], v46, s[52:55], s93 offen
    s_add_u32 s93, s85, s18
    buffer_load_dwordx4 v[92:95], v46, s[52:55], s93 offen
    s_waitcnt vmcnt(24)
    s_cmp_lg_u32 s64, 4
    s_cbranch_scc1 CKRG
    v_cmp_eq_u32 vcc, s38, v47
    s_nop 4
    s_cmp_eq_u32 vcc_lo, -1
    s_cbranch_scc0 CKSG
CKDG:
CKRG:
    s_barrier
    s_add_u32 m0, s27, 0
    s_add_u32 s93, s84, s19
    buffer_load_dwordx4 v46, s[52:55], s93 offen lds
    s_add_u32 m0, s28, 0
    s_add_u32 s93, s84, s19
    s_sub_u32 s93, s93, 28672
    buffer_load_dwordx4 v46, s[52:55], s93 offen lds
    s_add_u32 m0, s27, 1024
    s_add_u32 s93, s85, s19
    buffer_load_dwordx4 v46, s[52:55], s93 offen lds
    v_pk_mul_f32 v[28:29], v[96:97], v[96:97]
    v_pk_mul_f32 v[30:31], v[98:99], v[98:99]
    v_pk_fma_f32 v[28:29], v[28:29], s[72:73], v[36:37] op_sel_hi:[1,0,0]
    v_pk_fma_f32 v[30:31], v[30:31], s[72:73], v[36:37] op_sel_hi:[1,0,0]
    v_pk_mul_f32 v[28:29], v[28:29], v[96:97]
    v_pk_mul_f32 v[30:31], v[30:31], v[98:99]
    v_exp_f32 v28, v28
    v_exp_f32 v29, v29
    v_exp_f32 v30, v30
    v_exp_f32 v31, v31
    v_pk_mul_f32 v[32:33], v[96:97], v[128:129]
    v_pk_mul_f32 v[34:35], v[98:99], v[130:131]
    v_pk_add_f32 v[28:29], v[28:29], s[30:31] op_sel_hi:[1,0]
    v_pk_add_f32 v[30:31], v[30:31], s[30:31] op_sel_hi:[1,0]
    v_rcp_f32 v28, v28
    v_rcp_f32 v29, v29
    v_rcp_f32 v30, v30
    v_rcp_f32 v31, v31
    v_pk_mul_f32 v[28:29], v[28:29], v[32:33]
    v_pk_mul_f32 v[30:31], v[30:31], v[34:35]
    v_cvt_pk_bf16_f32 v96, v28, v29
    v_cvt_pk_bf16_f32 v97, v30, v31
    s_add_u32 m0, s28, 1024
    s_add_u32 s93, s85, s19
    s_sub_u32 s93, s93, 28672
    buffer_load_dwordx4 v46, s[52:55], s93 offen lds
    s_add_u32 m0, s27, 2048
    s_add_u32 s93, s84, s22
    buffer_load_dwordx4 v46, s[52:55], s93 offen lds
    s_add_u32 m0, s28, 2048
    s_add_u32 s93, s84, s22
    s_sub_u32 s93, s93, 28672
    buffer_load_dwordx4 v46, s[52:55], s93 offen lds
    v_pk_mul_f32 v[28:29], v[100:101], v[100:101]
    v_pk_mul_f32 v[30:31], v[102:103], v[102:103]
    v_pk_fma_f32 v[28:29], v[28:29], s[72:73], v[36:37] op_sel_hi:[1,0,0]
    v_pk_fma_f32 v[30:31], v[30:31], s[72:73], v[36:37] op_sel_hi:[1,0,0]
    v_pk_mul_f32 v[28:29], v[28:29], v[100:101]
    v_pk_mul_f32 v[30:31], v[30:31], v[102:103]
    v_exp_f32 v28, v28
    v_exp_f32 v29, v29
    v_exp_f32 v30, v30
    v_exp_f32 v31, v31
    v_pk_mul_f32 v[32:33], v[100:101], v[132:133]
    v_pk_mul_f32 v[34:35], v[102:103], v[134:135]
    v_pk_add_f32 v[28:29], v[28:29], s[30:31] op_sel_hi:[1,0]
    v_pk_add_f32 v[30:31], v[30:31], s[30:31] op_sel_hi:[1,0]
    v_rcp_f32 v28, v28
    v_rcp_f32 v29, v29
    v_rcp_f32 v30, v30
    v_rcp_f32 v31, v31
    v_pk_mul_f32 v[28:29], v[28:29], v[32:33]
    v_pk_mul_f32 v[30:31], v[30:31], v[34:35]
    v_cvt_pk_bf16_f32 v98, v28, v29
    v_cvt_pk_bf16_f32 v99, v30, v31
    s_add_u32 m0, s27, 3072
    s_add_u32 s93, s85, s22
    buffer_load_dwordx4 v46, s[52:55], s93 offen lds
    s_add_u32 m0, s28, 3072
    s_add_u32 s93, s85, s22
    s_sub_u32 s93, s93, 28672
    buffer_load_dwordx4 v46, s[52:55], s93 offen lds
    s_add_u32 m0, s27, 4096
    s_add_u32 s93, s84, s23
    buffer_load_dwordx4 v46, s[52:55], s93 offen lds
    v_pk_mul_f32 v[28:29], v[104:105], v[104:105]
    v_pk_mul_f32 v[30:31], v[106:107], v[106:107]
    v_pk_fma_f32 v[28:29], v[28:29], s[72:73], v[36:37] op_sel_hi:[1,0,0]
    v_pk_fma_f32 v[30:31], v[30:31], s[72:73], v[36:37] op_sel_hi:[1,0,0]
    v_pk_mul_f32 v[28:29], v[28:29], v[104:105]
    v_pk_mul_f32 v[30:31], v[30:31], v[106:107]
    v_exp_f32 v28, v28
    v_exp_f32 v29, v29
    v_exp_f32 v30, v30
    v_exp_f32 v31, v31
    v_pk_mul_f32 v[32:33], v[104:105], v[136:137]
    v_pk_mul_f32 v[34:35], v[106:107], v[138:139]
    v_pk_add_f32 v[28:29], v[28:29], s[30:31] op_sel_hi:[1,0]
    v_pk_add_f32 v[30:31], v[30:31], s[30:31] op_sel_hi:[1,0]
    v_rcp_f32 v28, v28
    v_rcp_f32 v29, v29
    v_rcp_f32 v30, v30
    v_rcp_f32 v31, v31
    v_pk_mul_f32 v[28:29], v[28:29], v[32:33]
    v_pk_mul_f32 v[30:31], v[30:31], v[34:35]
    v_cvt_pk_bf16_f32 v100, v28, v29
    v_cvt_pk_bf16_f32 v101, v30, v31
    s_add_u32 m0, s28, 4096
    s_add_u32 s93, s84, s23
    s_sub_u32 s93, s93, 28672
    buffer_load_dwordx4 v46, s[52:55], s93 offen lds
    s_add_u32 m0, s27, 5120
    s_add_u32 s93, s85, s23
    buffer_load_dwordx4 v46, s[52:55], s93 offen lds
    s_add_u32 m0, s28, 5120
    s_add_u32 s93, s85, s23
    s_sub_u32 s93, s93, 28672
    buffer_load_dwordx4 v46, s[52:55], s93 offen lds
    v_pk_mul_f32 v[28:29], v[108:109], v[108:109]
    v_pk_mul_f32 v[30:31], v[110:111], v[110:111]
    v_pk_fma_f32 v[28:29], v[28:29], s[72:73], v[36:37] op_sel_hi:[1,0,0]
    v_pk_fma_f32 v[30:31], v[30:31], s[72:73], v[36:37] op_sel_hi:[1,0,0]
    v_pk_mul_f32 v[28:29], v[28:29], v[108:109]
    v_pk_mul_f32 v[30:31], v[30:31], v[110:111]
    v_exp_f32 v28, v28
    v_exp_f32 v29, v29
    v_exp_f32 v30, v30
    v_exp_f32 v31, v31
    v_pk_mul_f32 v[32:33], v[108:109], v[140:141]
    v_pk_mul_f32 v[34:35], v[110:111], v[142:143]
    v_pk_add_f32 v[28:29], v[28:29], s[30:31] op_sel_hi:[1,0]
    v_pk_add_f32 v[30:31], v[30:31], s[30:31] op_sel_hi:[1,0]
    v_rcp_f32 v28, v28
    v_rcp_f32 v29, v29
    v_rcp_f32 v30, v30
    v_rcp_f32 v31, v31
    v_pk_mul_f32 v[28:29], v[28:29], v[32:33]
    v_pk_mul_f32 v[30:31], v[30:31], v[34:35]
    v_cvt_pk_bf16_f32 v102, v28, v29
    v_cvt_pk_bf16_f32 v103, v30, v31
    buffer_store_dwordx4 v[96:99], v37, s[52:55], s73 offen sc1
    buffer_store_dwordx4 v[100:103], v37, s[52:55], s73 offen offset:1024 sc1
    s_add_u32 m0, s27, 6144
    s_add_u32 s93, s84, s24
    buffer_load_dwordx4 v46, s[52:55], s93 offen lds
    s_add_u32 m0, s28, 6144
    s_add_u32 s93, s84, s24
    s_sub_u32 s93, s93, 28672
    buffer_load_dwordx4 v46, s[52:55], s93 offen lds
    s_add_u32 m0, s27, 7168
    s_add_u32 s93, s85, s24
    buffer_load_dwordx4 v46, s[52:55], s93 offen lds
    v_pk_mul_f32 v[28:29], v[112:113], v[112:113]
    v_pk_mul_f32 v[30:31], v[114:115], v[114:115]
    v_pk_fma_f32 v[28:29], v[28:29], s[72:73], v[36:37] op_sel_hi:[1,0,0]
    v_pk_fma_f32 v[30:31], v[30:31], s[72:73], v[36:37] op_sel_hi:[1,0,0]
    v_pk_mul_f32 v[28:29], v[28:29], v[112:113]
    v_pk_mul_f32 v[30:31], v[30:31], v[114:115]
    v_exp_f32 v28, v28
    v_exp_f32 v29, v29
    v_exp_f32 v30, v30
    v_exp_f32 v31, v31
    v_pk_mul_f32 v[32:33], v[112:113], v[144:145]
    v_pk_mul_f32 v[34:35], v[114:115], v[146:147]
    v_pk_add_f32 v[28:29], v[28:29], s[30:31] op_sel_hi:[1,0]
    v_pk_add_f32 v[30:31], v[30:31], s[30:31] op_sel_hi:[1,0]
    v_rcp_f32 v28, v28
    v_rcp_f32 v29, v29
    v_rcp_f32 v30, v30
    v_rcp_f32 v31, v31
    v_pk_mul_f32 v[28:29], v[28:29], v[32:33]
    v_pk_mul_f32 v[30:31], v[30:31], v[34:35]
    v_cvt_pk_bf16_f32 v112, v28, v29
    v_cvt_pk_bf16_f32 v113, v30, v31
    s_add_u32 m0, s28, 7168
    s_add_u32 s93, s85, s24
    s_sub_u32 s93, s93, 28672
    buffer_load_dwordx4 v46, s[52:55], s93 offen lds
    s_add_u32 m0, s27, 8192
    s_add_u32 s93, s84, s25
    buffer_load_dwordx4 v46, s[52:55], s93 offen lds
    s_add_u32 m0, s28, 8192
    s_add_u32 s93, s84, s25
    s_sub_u32 s93, s93, 28672
    buffer_load_dwordx4 v46, s[52:55], s93 offen lds
    v_pk_mul_f32 v[28:29], v[116:117], v[116:117]
    v_pk_mul_f32 v[30:31], v[118:119], v[118:119]
    v_pk_fma_f32 v[28:29], v[28:29], s[72:73], v[36:37] op_sel_hi:[1,0,0]
    v_pk_fma_f32 v[30:31], v[30:31], s[72:73], v[36:37] op_sel_hi:[1,0,0]
    v_pk_mul_f32 v[28:29], v[28:29], v[116:117]
    v_pk_mul_f32 v[30:31], v[30:31], v[118:119]
    v_exp_f32 v28, v28
    v_exp_f32 v29, v29
    v_exp_f32 v30, v30
    v_exp_f32 v31, v31
    v_pk_mul_f32 v[32:33], v[116:117], v[148:149]
    v_pk_mul_f32 v[34:35], v[118:119], v[150:151]
    v_pk_add_f32 v[28:29], v[28:29], s[30:31] op_sel_hi:[1,0]
    v_pk_add_f32 v[30:31], v[30:31], s[30:31] op_sel_hi:[1,0]
    v_rcp_f32 v28, v28
    v_rcp_f32 v29, v29
    v_rcp_f32 v30, v30
    v_rcp_f32 v31, v31
    v_pk_mul_f32 v[28:29], v[28:29], v[32:33]
    v_pk_mul_f32 v[30:31], v[30:31], v[34:35]
    v_cvt_pk_bf16_f32 v114, v28, v29
    v_cvt_pk_bf16_f32 v115, v30, v31
    s_add_u32 m0, s27, 9216
    s_add_u32 s93, s85, s25
    buffer_load_dwordx4 v46, s[52:55], s93 offen lds
    s_add_u32 m0, s28, 9216
    s_add_u32 s93, s85, s25
    s_sub_u32 s93, s93, 28672
    buffer_load_dwordx4 v46, s[52:55], s93 offen lds
    s_add_u32 m0, s27, 10240
    s_add_u32 s93, s84, s26
    buffer_load_dwordx4 v46, s[52:55], s93 offen lds
    v_pk_mul_f32 v[28:29], v[120:121], v[120:121]
    v_pk_mul_f32 v[30:31], v[122:123], v[122:123]
    v_pk_fma_f32 v[28:29], v[28:29], s[72:73], v[36:37] op_sel_hi:[1,0,0]
    v_pk_fma_f32 v[30:31], v[30:31], s[72:73], v[36:37] op_sel_hi:[1,0,0]
    v_pk_mul_f32 v[28:29], v[28:29], v[120:121]
    v_pk_mul_f32 v[30:31], v[30:31], v[122:123]
    v_exp_f32 v28, v28
    v_exp_f32 v29, v29
    v_exp_f32 v30, v30
    v_exp_f32 v31, v31
    v_pk_mul_f32 v[32:33], v[120:121], v[152:153]
    v_pk_mul_f32 v[34:35], v[122:123], v[154:155]
    v_pk_add_f32 v[28:29], v[28:29], s[30:31] op_sel_hi:[1,0]
    v_pk_add_f32 v[30:31], v[30:31], s[30:31] op_sel_hi:[1,0]
    v_rcp_f32 v28, v28
    v_rcp_f32 v29, v29
    v_rcp_f32 v30, v30
    v_rcp_f32 v31, v31
    v_pk_mul_f32 v[28:29], v[28:29], v[32:33]
    v_pk_mul_f32 v[30:31], v[30:31], v[34:35]
    v_cvt_pk_bf16_f32 v116, v28, v29
    v_cvt_pk_bf16_f32 v117, v30, v31
    s_add_u32 m0, s28, 10240
    s_add_u32 s93, s84, s26
    s_sub_u32 s93, s93, 28672
    buffer_load_dwordx4 v46, s[52:55], s93 offen lds
    s_add_u32 m0, s27, 11264
    s_add_u32 s93, s85, s26
    buffer_load_dwordx4 v46, s[52:55], s93 offen lds
    s_add_u32 m0, s28, 11264
    s_add_u32 s93, s85, s26
    s_sub_u32 s93, s93, 28672
    buffer_load_dwordx4 v46, s[52:55], s93 offen lds
    v_pk_mul_f32 v[28:29], v[124:125], v[124:125]
    v_pk_mul_f32 v[30:31], v[126:127], v[126:127]
    v_pk_fma_f32 v[28:29], v[28:29], s[72:73], v[36:37] op_sel_hi:[1,0,0]
    v_pk_fma_f32 v[30:31], v[30:31], s[72:73], v[36:37] op_sel_hi:[1,0,0]
    v_pk_mul_f32 v[28:29], v[28:29], v[124:125]
    v_pk_mul_f32 v[30:31], v[30:31], v[126:127]
    v_exp_f32 v28, v28
    v_exp_f32 v29, v29
    v_exp_f32 v30, v30
    v_exp_f32 v31, v31
    v_pk_mul_f32 v[32:33], v[124:125], v[156:157]
    v_pk_mul_f32 v[34:35], v[126:127], v[158:159]
    v_pk_add_f32 v[28:29], v[28:29], s[30:31] op_sel_hi:[1,0]
    v_pk_add_f32 v[30:31], v[30:31], s[30:31] op_sel_hi:[1,0]
    v_rcp_f32 v28, v28
    v_rcp_f32 v29, v29
    v_rcp_f32 v30, v30
    v_rcp_f32 v31, v31
    v_pk_mul_f32 v[28:29], v[28:29], v[32:33]
    v_pk_mul_f32 v[30:31], v[30:31], v[34:35]
    v_cvt_pk_bf16_f32 v118, v28, v29
    v_cvt_pk_bf16_f32 v119, v30, v31
    buffer_store_dwordx4 v[112:115], v37, s[52:55], s74 offen sc1
    buffer_store_dwordx4 v[116:119], v37, s[52:55], s74 offen offset:1024 sc1
K1_JOIN:
    s_waitcnt vmcnt(0)
    s_barrier
    v_mov_b32 v2, v46
    s_cmp_lg_u32 s64, 4
    s_cbranch_scc1 K1_NOPOLL
    s_setprio 3
    s_lshl_b32 s80, s65, 7
    s_add_u32 s80, s80, 13543424
    s_lshl_b32 s71, s66, 2
    v_mov_b32 v3, s71
    v_mov_b32 v4, s38
    buffer_store_dword v4, v3, s[52:55], s80 offen sc1
    v_and_b32 v5, 15, v1
    v_lshlrev_b32 v5, 2, v5
    s_mov_b32 s81, 0
POLL3:
    buffer_load_dword v6, v5, s[52:55], s80 offen sc1
    s_waitcnt vmcnt(0)
    v_cmp_eq_u32 vcc, s38, v6
    s_nop 4
    s_andn2_b32 s71, 0x3fff, vcc_lo
    s_cbranch_scc0 POLLD3
    s_add_u32 s81, s81, 1
    s_cmp_gt_u32 s81, 0x10000
    s_cbranch_scc1 POLLD3
    s_sleep 1
    s_branch POLL3
POLLD3:
    s_setprio 0
K1_NOPOLL:
    s_cmp_ge_u32 s64, 4
    s_cbranch_scc1 K1_NOW
    s_add_u32 s93, s82, s12
    buffer_load_dwordx4 v[160:163], v2, s[52:55], s93 offen
    s_add_u32 s93, s83, s12
    buffer_load_dwordx4 v[164:167], v2, s[52:55], s93 offen
    s_add_u32 s93, s82, s13
    buffer_load_dwordx4 v[168:171], v2, s[52:55], s93 offen
    s_add_u32 s93, s83, s13
    buffer_load_dwordx4 v[172:175], v2, s[52:55], s93 offen
    s_add_u32 s93, s82, s14
    buffer_load_dwordx4 v[176:179], v2, s[52:55], s93 offen
    s_add_u32 s93, s83, s14
    buffer_load_dwordx4 v[180:183], v2, s[52:55], s93 offen
    s_add_u32 s93, s82, s15
    buffer_load_dwordx4 v[184:187], v2, s[52:55], s93 offen
    s_add_u32 s93, s83, s15
    buffer_load_dwordx4 v[188:191], v2, s[52:55], s93 offen
K1_NOW:
    s_mov_b32 s60, s20
    s_and_b32 s61, s21, 0xffff
    s_mov_b32 s62, 896
    s_mov_b32 s63, 0x20000
    s_mov_b32 s44, s32
    s_and_b32 s45, s33, 0xffff
    s_mov_b32 s46, 3670016
    s_mov_b32 s47, 0x20000
    v_and_b32 v4, 31, v1
    v_and_b32 v5, 3, v4
    v_lshrrev_b32 v6, 3, v4
    v_lshl_add_u32 v5, v6, 2, v5
    v_bfe_u32 v6, v4, 2, 1
    v_lshl_add_u32 v5, v6, 4, v5
    s_lshl_b32 s73, s94, 6
    v_add_lshl_u32 v5, v5, s73, 2
    s_mov_b32 s74, 13418496
    buffer_load_dword v8, v5, s[52:55], s74 offen sc1
    buffer_load_dword v9, v5, s[52:55], s74 offen offset:128 sc1
    v_lshrrev_b32 v4, 4, v1
    v_and_b32 v6, 15, v1
    s_lshl_b32 s75, s95, 7
    v_lshl_add_u32 v7, v6, 3, s75
    buffer_load_dwordx2 v[10:11], v7, s[60:63], 0 offen
    s_and_b32 s75, s64, 3
    s_lshl_b32 s75, s75, 2
    s_lshr_b32 s76, s64, 2
    s_lshl_b32 s76, s76, 5
    s_add_u32 s75, s75, s76
    s_add_u32 s75, s75, s73
    v_add_u32 v3, s75, v4
    v_lshlrev_b32 v4, 2, v3
    v_mul_u32_u24 v3, 896, v3
    v_add_u32 v3, v3, v7
    s_movk_i32 s77, 14336
    buffer_load_dwordx2 v[12:13], v3, s[40:43], 0 offen
    buffer_load_dwordx2 v[14:15], v3, s[40:43], s77 offen
    buffer_load_dword v6, v4, s[52:55], s74 offen sc1
    buffer_load_dword v7, v4, s[52:55], s74 offen offset:64 sc1
    s_barrier
    s_add_u32 s93, s86, s4
    buffer_load_dwordx4 v[16:19], v2, s[52:55], s93 offen
    s_add_u32 s93, s87, s4
    buffer_load_dwordx4 v[20:23], v2, s[52:55], s93 offen
    s_add_u32 s93, s86, s5
    buffer_load_dwordx4 v[24:27], v2, s[52:55], s93 offen
    s_add_u32 s93, s87, s5
    buffer_load_dwordx4 v[28:31], v2, s[52:55], s93 offen
    s_add_u32 s93, s86, s6
    buffer_load_dwordx4 v[32:35], v2, s[52:55], s93 offen
    s_add_u32 s93, s87, s6
    buffer_load_dwordx4 v[36:39], v2, s[52:55], s93 offen
    s_add_u32 s93, s86, s7
    buffer_load_dwordx4 v[40:43], v2, s[52:55], s93 offen
    s_add_u32 s93, s87, s7
    buffer_load_dwordx4 v[44:47], v2, s[52:55], s93 offen
    s_add_u32 s93, s86, s8
    buffer_load_dwordx4 v[48:51], v2, s[52:55], s93 offen
    s_add_u32 s93, s87, s8
    buffer_load_dwordx4 v[52:55], v2, s[52:55], s93 offen
    s_add_u32 s93, s86, s9
    buffer_load_dwordx4 v[56:59], v2, s[52:55], s93 offen
    s_add_u32 s93, s87, s9
    buffer_load_dwordx4 v[60:63], v2, s[52:55], s93 offen
    s_add_u32 s93, s86, s10
    buffer_load_dwordx4 v[64:67], v2, s[52:55], s93 offen
    s_add_u32 s93, s87, s10
    buffer_load_dwordx4 v[68:71], v2, s[52:55], s93 offen
    s_lshl_b32 s75, s64, 14
    v_add_u32 v5, s75, v2
    s_waitcnt vmcnt(12)
    v_mfma_f32_32x32x16_bf16 v[96:111], v[192:195], v[16:19], 0
    v_mfma_f32_32x32x16_bf16 v[112:127], v[192:195], v[20:23], 0
    v_mfma_f32_32x32x16_bf16 v[128:143], v[196:199], v[16:19], 0
    v_mfma_f32_32x32x16_bf16 v[144:159], v[196:199], v[20:23], 0
    s_add_u32 s93, s86, s11
    buffer_load_dwordx4 v[16:19], v2, s[52:55], s93 offen
    s_add_u32 s93, s87, s11
    buffer_load_dwordx4 v[20:23], v2, s[52:55], s93 offen
    s_add_u32 s93, s86, s12
    buffer_load_dwordx4 v[192:195], v2, s[52:55], s93 offen
    s_add_u32 s93, s87, s12
    buffer_load_dwordx4 v[196:199], v2, s[52:55], s93 offen
    s_waitcnt vmcnt(14)
    v_mfma_f32_32x32x16_bf16 v[96:111], v[200:203], v[24:27], v[96:111]
    v_mfma_f32_32x32x16_bf16 v[112:127], v[200:203], v[28:31], v[112:127]
    v_mfma_f32_32x32x16_bf16 v[128:143], v[204:207], v[24:27], v[128:143]
    v_mfma_f32_32x32x16_bf16 v[144:159], v[204:207], v[28:31], v[144:159]
    s_add_u32 s93, s86, s13
    buffer_load_dwordx4 v[24:27], v2, s[52:55], s93 offen
    s_add_u32 s93, s87, s13
    buffer_load_dwordx4 v[28:31], v2, s[52:55], s93 offen
    s_add_u32 s93, s86, s14
    buffer_load_dwordx4 v[200:203], v2, s[52:55], s93 offen
    s_add_u32 s93, s87, s14
    buffer_load_dwordx4 v[204:207], v2, s[52:55], s93 offen
    s_waitcnt vmcnt(16)
    v_mfma_f32_32x32x16_bf16 v[96:111], v[208:211], v[32:35], v[96:111]
    v_mfma_f32_32x32x16_bf16 v[112:127], v[208:211], v[36:39], v[112:127]
    v_mfma_f32_32x32x16_bf16 v[128:143], v[212:215], v[32:35], v[128:143]
    v_mfma_f32_32x32x16_bf16 v[144:159], v[212:215], v[36:39], v[144:159]
    s_add_u32 s93, s86, s15
    buffer_load_dwordx4 v[32:35], v2, s[52:55], s93 offen
    s_add_u32 s93, s87, s15
    buffer_load_dwordx4 v[36:39], v2, s[52:55], s93 offen
    s_add_u32 s93, s86, s16
    buffer_load_dwordx4 v[208:211], v2, s[52:55], s93 offen
    s_add_u32 s93, s87, s16
    buffer_load_dwordx4 v[212:215], v2, s[52:55], s93 offen
    s_waitcnt vmcnt(18)
    v_mfma_f32_32x32x16_bf16 v[96:111], v[216:219], v[40:43], v[96:111]
    v_mfma_f32_32x32x16_bf16 v[112:127], v[216:219], v[44:47], v[112:127]
    v_mfma_f32_32x32x16_bf16 v[128:143], v[220:223], v[40:43], v[128:143]
    v_mfma_f32_32x32x16_bf16 v[144:159], v[220:223], v[44:47], v[144:159]
    s_add_u32 s93, s86, s17
    buffer_load_dwordx4 v[40:43], v2, s[52:55], s93 offen
    s_add_u32 s93, s87, s17
    buffer_load_dwordx4 v[44:47], v2, s[52:55], s93 offen
    s_add_u32 s93, s88, s18
    buffer_load_dwordx4 v[216:219], v2, s[52:55], s93 offen
    s_add_u32 s93, s89, s18
    buffer_load_dwordx4 v[220:223], v2, s[52:55], s93 offen
    s_waitcnt vmcnt(20)
    v_mfma_f32_32x32x16_bf16 v[96:111], v[224:227], v[48:51], v[96:111]
    v_mfma_f32_32x32x16_bf16 v[112:127], v[224:227], v[52:55], v[112:127]
    v_mfma_f32_32x32x16_bf16 v[128:143], v[228:231], v[48:51], v[128:143]
    v_mfma_f32_32x32x16_bf16 v[144:159], v[228:231], v[52:55], v[144:159]
    s_add_u32 s93, s88, s19
    buffer_load_dwordx4 v[48:51], v2, s[52:55], s93 offen
    s_add_u32 s93, s89, s19
    buffer_load_dwordx4 v[52:55], v2, s[52:55], s93 offen
    s_add_u32 s93, s88, s22
    buffer_load_dwordx4 v[224:227], v2, s[52:55], s93 offen
    s_add_u32 s93, s89, s22
    buffer_load_dwordx4 v[228:231], v2, s[52:55], s93 offen
    s_waitcnt vmcnt(22)
    v_mfma_f32_32x32x16_bf16 v[96:111], v[232:235], v[56:59], v[96:111]
    v_mfma_f32_32x32x16_bf16 v[112:127], v[232:235], v[60:63], v[112:127]
    v_mfma_f32_32x32x16_bf16 v[128:143], v[236:239], v[56:59], v[128:143]
    v_mfma_f32_32x32x16_bf16 v[144:159], v[236:239], v[60:63], v[144:159]
    s_add_u32 s93, s88, s23
    buffer_load_dwordx4 v[56:59], v2, s[52:55], s93 offen
    s_add_u32 s93, s89, s23
    buffer_load_dwordx4 v[60:63], v2, s[52:55], s93 offen
    s_add_u32 s93, s88, s24
    buffer_load_dwordx4 v[232:235], v2, s[52:55], s93 offen
    s_add_u32 s93, s89, s24
    buffer_load_dwordx4 v[236:239], v2, s[52:55], s93 offen
    s_waitcnt vmcnt(24)
    v_mfma_f32_32x32x16_bf16 v[96:111], v[240:243], v[64:67], v[96:111]
    v_mfma_f32_32x32x16_bf16 v[112:127], v[240:243], v[68:71], v[112:127]
    v_mfma_f32_32x32x16_bf16 v[128:143], v[244:247], v[64:67], v[128:143]
    v_mfma_f32_32x32x16_bf16 v[144:159], v[244:247], v[68:71], v[144:159]
    s_add_u32 s93, s88, s25
    buffer_load_dwordx4 v[64:67], v2, s[52:55], s93 offen
    s_add_u32 s93, s89, s25
    buffer_load_dwordx4 v[68:71], v2, s[52:55], s93 offen
    s_add_u32 s93, s88, s26
    buffer_load_dwordx4 v[240:243], v2, s[52:55], s93 offen
    s_add_u32 s93, s89, s26
    buffer_load_dwordx4 v[244:247], v2, s[52:55], s93 offen
    s_waitcnt vmcnt(26)
    v_mfma_f32_32x32x16_bf16 v[96:111], v[248:251], v[16:19], v[96:111]
    v_mfma_f32_32x32x16_bf16 v[112:127], v[248:251], v[20:23], v[112:127]
    v_mfma_f32_32x32x16_bf16 v[128:143], v[252:255], v[16:19], v[128:143]
    v_mfma_f32_32x32x16_bf16 v[144:159], v[252:255], v[20:23], v[144:159]
    s_waitcnt vmcnt(24)
    v_mfma_f32_32x32x16_bf16 v[96:111], v[160:163], v[192:195], v[96:111]
    v_mfma_f32_32x32x16_bf16 v[112:127], v[160:163], v[196:199], v[112:127]
    v_mfma_f32_32x32x16_bf16 v[128:143], v[164:167], v[192:195], v[128:143]
    v_mfma_f32_32x32x16_bf16 v[144:159], v[164:167], v[196:199], v[144:159]
    ds_read_b128 v[248:251], v5 offset:0
    ds_read_b128 v[252:255], v5 offset:1024
    s_waitcnt vmcnt(22)
    v_mfma_f32_32x32x16_bf16 v[96:111], v[168:171], v[24:27], v[96:111]
    v_mfma_f32_32x32x16_bf16 v[112:127], v[168:171], v[28:31], v[112:127]
    v_mfma_f32_32x32x16_bf16 v[128:143], v[172:175], v[24:27], v[128:143]
    v_mfma_f32_32x32x16_bf16 v[144:159], v[172:175], v[28:31], v[144:159]
    ds_read_b128 v[160:163], v5 offset:2048
    ds_read_b128 v[164:167], v5 offset:3072
    s_waitcnt vmcnt(20)
    v_mfma_f32_32x32x16_bf16 v[96:111], v[176:179], v[200:203], v[96:111]
    v_mfma_f32_32x32x16_bf16 v[112:127], v[176:179], v[204:207], v[112:127]
    v_mfma_f32_32x32x16_bf16 v[128:143], v[180:183], v[200:203], v[128:143]
    v_mfma_f32_32x32x16_bf16 v[144:159], v[180:183], v[204:207], v[144:159]
    ds_read_b128 v[168:171], v5 offset:4096
    ds_read_b128 v[172:175], v5 offset:5120
    s_waitcnt vmcnt(18)
    v_mfma_f32_32x32x16_bf16 v[96:111], v[184:187], v[32:35], v[96:111]
    v_mfma_f32_32x32x16_bf16 v[112:127], v[184:187], v[36:39], v[112:127]
    v_mfma_f32_32x32x16_bf16 v[128:143], v[188:191], v[32:35], v[128:143]
    v_mfma_f32_32x32x16_bf16 v[144:159], v[188:191], v[36:39], v[144:159]
    ds_read_b128 v[176:179], v5 offset:6144
    ds_read_b128 v[180:183], v5 offset:7168
    s_waitcnt vmcnt(16)
    v_mfma_f32_32x32x16_bf16 v[96:111], v[72:75], v[208:211], v[96:111]
    v_mfma_f32_32x32x16_bf16 v[112:127], v[72:75], v[212:215], v[112:127]
    v_mfma_f32_32x32x16_bf16 v[128:143], v[76:79], v[208:211], v[128:143]
    v_mfma_f32_32x32x16_bf16 v[144:159], v[76:79], v[212:215], v[144:159]
    ds_read_b128 v[184:187], v5 offset:8192
    ds_read_b128 v[188:191], v5 offset:9216
    s_waitcnt vmcnt(14)
    v_mfma_f32_32x32x16_bf16 v[96:111], v[80:83], v[40:43], v[96:111]
    v_mfma_f32_32x32x16_bf16 v[112:127], v[80:83], v[44:47], v[112:127]
    v_mfma_f32_32x32x16_bf16 v[128:143], v[84:87], v[40:43], v[128:143]
    v_mfma_f32_32x32x16_bf16 v[144:159], v[84:87], v[44:47], v[144:159]
    ds_read_b128 v[72:75], v5 offset:10240
    ds_read_b128 v[76:79], v5 offset:11264
    s_waitcnt vmcnt(12)
    v_sub_f32 v4, 1.0, v8
    v_sub_f32 v5, 1.0, v9
    v_cvt_pk_bf16_f32 v4, v4, v5
    v_and_b32 v5, 0xffff0000, v4
    v_lshlrev_b32 v4, 16, v4
    s_nop 7
    v_pk_mul_f32 v[96:97], v[4:5], v[96:97] op_sel_hi:[0,1]
    v_pk_mul_f32 v[98:99], v[4:5], v[98:99] op_sel_hi:[0,1]
    v_pk_mul_f32 v[100:101], v[4:5], v[100:101] op_sel_hi:[0,1]
    v_pk_mul_f32 v[102:103], v[4:5], v[102:103] op_sel_hi:[0,1]
    v_pk_mul_f32 v[104:105], v[4:5], v[104:105] op_sel_hi:[0,1]
    v_pk_mul_f32 v[106:107], v[4:5], v[106:107] op_sel_hi:[0,1]
    v_pk_mul_f32 v[108:109], v[4:5], v[108:109] op_sel_hi:[0,1]
    v_pk_mul_f32 v[110:111], v[4:5], v[110:111] op_sel_hi:[0,1]
    v_pk_mul_f32 v[112:113], v[4:5], v[112:113] op_sel:[1,0]
    v_pk_mul_f32 v[114:115], v[4:5], v[114:115] op_sel:[1,0]
    v_pk_mul_f32 v[116:117], v[4:5], v[116:117] op_sel:[1,0]
    v_pk_mul_f32 v[118:119], v[4:5], v[118:119] op_sel:[1,0]
    v_pk_mul_f32 v[120:121], v[4:5], v[120:121] op_sel:[1,0]
    v_pk_mul_f32 v[122:123], v[4:5], v[122:123] op_sel:[1,0]
    v_pk_mul_f32 v[124:125], v[4:5], v[124:125] op_sel:[1,0]
    v_pk_mul_f32 v[126:127], v[4:5], v[126:127] op_sel:[1,0]
    v_pk_mul_f32 v[128:129], v[4:5], v[128:129] op_sel_hi:[0,1]
    v_pk_mul_f32 v[130:131], v[4:5], v[130:131] op_sel_hi:[0,1]
    v_pk_mul_f32 v[132:133], v[4:5], v[132:133] op_sel_hi:[0,1]
    v_pk_mul_f32 v[134:135], v[4:5], v[134:135] op_sel_hi:[0,1]
    v_pk_mul_f32 v[136:137], v[4:5], v[136:137] op_sel_hi:[0,1]
    v_pk_mul_f32 v[138:139], v[4:5], v[138:139] op_sel_hi:[0,1]
    v_pk_mul_f32 v[140:141], v[4:5], v[140:141] op_sel_hi:[0,1]
    v_pk_mul_f32 v[142:143], v[4:5], v[142:143] op_sel_hi:[0,1]
    v_pk_mul_f32 v[144:145], v[4:5], v[144:145] op_sel:[1,0]
    v_pk_mul_f32 v[146:147], v[4:5], v[146:147] op_sel:[1,0]
    v_pk_mul_f32 v[148:149], v[4:5], v[148:149] op_sel:[1,0]
    v_pk_mul_f32 v[150:151], v[4:5], v[150:151] op_sel:[1,0]
    v_pk_mul_f32 v[152:153], v[4:5], v[152:153] op_sel:[1,0]
    v_pk_mul_f32 v[154:155], v[4:5], v[154:155] op_sel:[1,0]
    v_pk_mul_f32 v[156:157], v[4:5], v[156:157] op_sel:[1,0]
    v_pk_mul_f32 v[158:159], v[4:5], v[158:159] op_sel:[1,0]
    s_waitcnt lgkmcnt(0)
    s_nop 0
    v_mfma_f32_32x32x16_bf16 v[96:111], v[88:91], v[216:219], v[96:111]
    v_mfma_f32_32x32x16_bf16 v[112:127], v[88:91], v[220:223], v[112:127]
    v_mfma_f32_32x32x16_bf16 v[128:143], v[92:95], v[216:219], v[128:143]
    v_mfma_f32_32x32x16_bf16 v[144:159], v[92:95], v[220:223], v[144:159]
    s_waitcnt vmcnt(10)
    v_mfma_f32_32x32x16_bf16 v[96:111], v[248:251], v[48:51], v[96:111]
    v_mfma_f32_32x32x16_bf16 v[112:127], v[248:251], v[52:55], v[112:127]
    v_mfma_f32_32x32x16_bf16 v[128:143], v[252:255], v[48:51], v[128:143]
    v_mfma_f32_32x32x16_bf16 v[144:159], v[252:255], v[52:55], v[144:159]
    s_waitcnt vmcnt(8)
    v_mfma_f32_32x32x16_bf16 v[96:111], v[160:163], v[224:227], v[96:111]
    v_mfma_f32_32x32x16_bf16 v[112:127], v[160:163], v[228:231], v[112:127]
    v_mfma_f32_32x32x16_bf16 v[128:143], v[164:167], v[224:227], v[128:143]
    v_mfma_f32_32x32x16_bf16 v[144:159], v[164:167], v[228:231], v[144:159]
    s_waitcnt vmcnt(6)
    v_mfma_f32_32x32x16_bf16 v[96:111], v[168:171], v[56:59], v[96:111]
    v_mfma_f32_32x32x16_bf16 v[112:127], v[168:171], v[60:63], v[112:127]
    v_mfma_f32_32x32x16_bf16 v[128:143], v[172:175], v[56:59], v[128:143]
    v_mfma_f32_32x32x16_bf16 v[144:159], v[172:175], v[60:63], v[144:159]
    s_waitcnt vmcnt(4)
    v_mfma_f32_32x32x16_bf16 v[96:111], v[176:179], v[232:235], v[96:111]
    v_mfma_f32_32x32x16_bf16 v[112:127], v[176:179], v[236:239], v[112:127]
    v_mfma_f32_32x32x16_bf16 v[128:143], v[180:183], v[232:235], v[128:143]
    v_mfma_f32_32x32x16_bf16 v[144:159], v[180:183], v[236:239], v[144:159]
    s_waitcnt vmcnt(2)
    v_mfma_f32_32x32x16_bf16 v[96:111], v[184:187], v[64:67], v[96:111]
    v_mfma_f32_32x32x16_bf16 v[112:127], v[184:187], v[68:71], v[112:127]
    v_mfma_f32_32x32x16_bf16 v[128:143], v[188:191], v[64:67], v[128:143]
    v_mfma_f32_32x32x16_bf16 v[144:159], v[188:191], v[68:71], v[144:159]
    s_waitcnt vmcnt(0)
    v_mfma_f32_32x32x16_bf16 v[96:111], v[72:75], v[240:243], v[96:111]
    v_mfma_f32_32x32x16_bf16 v[112:127], v[72:75], v[244:247], v[112:127]
    v_mfma_f32_32x32x16_bf16 v[128:143], v[76:79], v[240:243], v[128:143]
    v_mfma_f32_32x32x16_bf16 v[144:159], v[76:79], v[244:247], v[144:159]
    v_and_b32 v16, 31, v1
    v_lshrrev_b32 v17, 5, v1
    v_and_b32 v18, 7, v1
    v_xor_b32 v17, v17, v18
    s_lshl_b32 s75, s64, 14
    v_lshl_add_u32 v16, v16, 8, s75
    v_xor_b32 v18, 0, v17
    v_lshl_add_u32 v20, v18, 4, v16
    v_xor_b32 v18, 2, v17
    v_lshl_add_u32 v21, v18, 4, v16
    v_xor_b32 v18, 4, v17
    v_lshl_add_u32 v22, v18, 4, v16
    v_xor_b32 v18, 6, v17
    v_lshl_add_u32 v23, v18, 4, v16
    ds_write_b128 v20, v[96:99] offset:0
    ds_write_b128 v21, v[100:103] offset:0
    ds_write_b128 v22, v[104:107] offset:0
    ds_write_b128 v23, v[108:111] offset:0
    ds_write_b128 v20, v[112:115] offset:8192
    ds_write_b128 v21, v[116:119] offset:8192
    ds_write_b128 v22, v[120:123] offset:8192
    ds_write_b128 v23, v[124:127] offset:8192
    ds_write_b128 v20, v[128:131] offset:128
    ds_write_b128 v21, v[132:135] offset:128
    ds_write_b128 v22, v[136:139] offset:128
    ds_write_b128 v23, v[140:143] offset:128
    ds_write_b128 v20, v[144:147] offset:8320
    ds_write_b128 v21, v[148:151] offset:8320
    ds_write_b128 v22, v[152:155] offset:8320
    ds_write_b128 v23, v[156:159] offset:8320
    v_lshrrev_b32 v16, 4, v1
    s_lshl_b32 s75, s64, 3
    v_add_u32 v16, s75, v16
    v_and_b32 v18, 15, v1
    v_add_u32 v17, 0, v16
    v_and_b32 v19, 7, v17
    v_xor_b32 v19, v19, v18
    v_lshlrev_b32 v19, 4, v19
    v_lshl_add_u32 v24, v17, 8, v19
    v_add_u32 v26, 65536, v24
    v_add_u32 v17, 4, v16
    v_and_b32 v19, 7, v17
    v_xor_b32 v19, v19, v18
    v_lshlrev_b32 v19, 4, v19
    v_lshl_add_u32 v25, v17, 8, v19
    v_add_u32 v27, 65536, v25
    v_lshlrev_b32 v3, 1, v3
    v_lshlrev_b32 v16, 16, v10
    v_and_b32 v17, 0xffff0000, v10
    v_lshlrev_b32 v18, 16, v11
    v_and_b32 v19, 0xffff0000, v11
    v_lshlrev_b32 v28, 16, v12
    v_and_b32 v29, 0xffff0000, v12
    v_lshlrev_b32 v30, 16, v13
    v_and_b32 v31, 0xffff0000, v13
    v_mul_f32 v28, v28, v16
    v_mul_f32 v29, v29, v17
    v_mul_f32 v30, v30, v18
    v_mul_f32 v31, v31, v19
    v_cvt_pk_bf16_f32 v12, v28, v29
    v_cvt_pk_bf16_f32 v13, v30, v31
    v_lshlrev_b32 v28, 16, v12
    v_and_b32 v29, 0xffff0000, v12
    v_lshlrev_b32 v30, 16, v13
    v_and_b32 v31, 0xffff0000, v13
    v_mul_f32 v28, v28, v6
    v_mul_f32 v29, v29, v6
    v_mul_f32 v30, v30, v6
    v_mul_f32 v31, v31, v6
    v_lshlrev_b32 v32, 16, v14
    v_and_b32 v33, 0xffff0000, v14
    v_lshlrev_b32 v34, 16, v15
    v_and_b32 v35, 0xffff0000, v15
    v_mul_f32 v32, v32, v16
    v_mul_f32 v33, v33, v17
    v_mul_f32 v34, v34, v18
    v_mul_f32 v35, v35, v19
    v_cvt_pk_bf16_f32 v14, v32, v33
    v_cvt_pk_bf16_f32 v15, v34, v35
    v_lshlrev_b32 v32, 16, v14
    v_and_b32 v33, 0xffff0000, v14
    v_lshlrev_b32 v34, 16, v15
    v_and_b32 v35, 0xffff0000, v15
    v_mul_f32 v32, v32, v7
    v_mul_f32 v33, v33, v7
    v_mul_f32 v34, v34, v7
    v_mul_f32 v35, v35, v7
    s_waitcnt lgkmcnt(0)
    s_cmp_ge_u32 s64, 4
    s_cbranch_scc1 K1_RALL
    v_mov_b32 v16, 157696
    v_mov_b32 v17, 1
    ds_add_u32 v16, v17 offset:4
    s_mov_b32 s81, 0
K1_RSP:
    ds_read_b32 v17, v16 offset:4
    s_waitcnt lgkmcnt(0)
    v_readfirstlane_b32 s71, v17
    s_add_u32 s81, s81, 1
    s_cmp_gt_u32 s81, 0x40000
    s_cbranch_scc1 K1_RSD
    s_cmp_eq_u32 s71, 256
    s_cbranch_scc1 K1_RSD
    s_sleep 2
    s_branch K1_RSP
K1_RSD:
    ds_read_b128 v[48:51], v24 offset:0
    ds_read_b128 v[52:55], v24 offset:16384
    ds_read_b128 v[56:59], v24 offset:32768
    ds_read_b128 v[60:63], v24 offset:49152
    ds_read_b128 v[80:83], v25 offset:0
    ds_read_b128 v[84:87], v25 offset:16384
    ds_read_b128 v[88:91], v25 offset:32768
    ds_read_b128 v[92:95], v25 offset:49152
    s_waitcnt lgkmcnt(6)
    v_pk_add_f32 v[28:29], v[28:29], v[48:49]
    v_pk_add_f32 v[30:31], v[30:31], v[50:51]
    v_pk_add_f32 v[28:29], v[28:29], v[52:53]
    v_pk_add_f32 v[30:31], v[30:31], v[54:55]
    s_waitcnt lgkmcnt(4)
    v_pk_add_f32 v[28:29], v[28:29], v[56:57]
    v_pk_add_f32 v[30:31], v[30:31], v[58:59]
    v_pk_add_f32 v[28:29], v[28:29], v[60:61]
    v_pk_add_f32 v[30:31], v[30:31], v[62:63]
    s_waitcnt lgkmcnt(2)
    v_pk_add_f32 v[32:33], v[32:33], v[80:81]
    v_pk_add_f32 v[34:35], v[34:35], v[82:83]
    v_pk_add_f32 v[32:33], v[32:33], v[84:85]
    v_pk_add_f32 v[34:35], v[34:35], v[86:87]
    s_waitcnt lgkmcnt(0)
    v_pk_add_f32 v[32:33], v[32:33], v[88:89]
    v_pk_add_f32 v[34:35], v[34:35], v[90:91]
    v_pk_add_f32 v[32:33], v[32:33], v[92:93]
    v_pk_add_f32 v[34:35], v[34:35], v[94:95]
    s_barrier
    ds_read_b128 v[64:67], v26 offset:0
    ds_read_b128 v[68:71], v26 offset:16384
    ds_read_b128 v[72:75], v26 offset:32768
    ds_read_b128 v[76:79], v26 offset:49152
    ds_read_b128 v[96:99], v27 offset:0
    ds_read_b128 v[100:103], v27 offset:16384
    ds_read_b128 v[104:107], v27 offset:32768
    ds_read_b128 v[108:111], v27 offset:49152
    s_waitcnt lgkmcnt(6)
    v_pk_add_f32 v[28:29], v[28:29], v[64:65]
    v_pk_add_f32 v[30:31], v[30:31], v[66:67]
    v_pk_add_f32 v[28:29], v[28:29], v[68:69]
    v_pk_add_f32 v[30:31], v[30:31], v[70:71]
    s_waitcnt lgkmcnt(4)
    v_pk_add_f32 v[28:29], v[28:29], v[72:73]
    v_pk_add_f32 v[30:31], v[30:31], v[74:75]
    v_pk_add_f32 v[28:29], v[28:29], v[76:77]
    v_pk_add_f32 v[30:31], v[30:31], v[78:79]
    s_mov_b32 s77, 0
    buffer_store_dwordx4 v[28:31], v3, s[44:47], s77 offen
    s_waitcnt lgkmcnt(2)
    v_pk_add_f32 v[32:33], v[32:33], v[96:97]
    v_pk_add_f32 v[34:35], v[34:35], v[98:99]
    v_pk_add_f32 v[32:33], v[32:33], v[100:101]
    v_pk_add_f32 v[34:35], v[34:35], v[102:103]
    s_waitcnt lgkmcnt(0)
    v_pk_add_f32 v[32:33], v[32:33], v[104:105]
    v_pk_add_f32 v[34:35], v[34:35], v[106:107]
    v_pk_add_f32 v[32:33], v[32:33], v[108:109]
    v_pk_add_f32 v[34:35], v[34:35], v[110:111]
    s_mov_b32 s77, 28672
    buffer_store_dwordx4 v[32:35], v3, s[44:47], s77 offen
    s_branch K1_RE
K1_RALL:
    s_barrier
    ds_read_b128 v[48:51], v24 offset:0
    ds_read_b128 v[52:55], v24 offset:16384
    ds_read_b128 v[56:59], v24 offset:32768
    ds_read_b128 v[60:63], v24 offset:49152
    ds_read_b128 v[64:67], v26 offset:0
    ds_read_b128 v[68:71], v26 offset:16384
    ds_read_b128 v[72:75], v26 offset:32768
    ds_read_b128 v[76:79], v26 offset:49152
    ds_read_b128 v[80:83], v25 offset:0
    ds_read_b128 v[84:87], v25 offset:16384
    ds_read_b128 v[88:91], v25 offset:32768
    ds_read_b128 v[92:95], v25 offset:49152
    ds_read_b128 v[96:99], v27 offset:0
    ds_read_b128 v[100:103], v27 offset:16384
    ds_read_b128 v[104:107], v27 offset:32768
    ds_read_b128 v[108:111], v27 offset:49152
    s_waitcnt lgkmcnt(14)
    v_pk_add_f32 v[28:29], v[28:29], v[48:49]
    v_pk_add_f32 v[30:31], v[30:31], v[50:51]
    v_pk_add_f32 v[28:29], v[28:29], v[52:53]
    v_pk_add_f32 v[30:31], v[30:31], v[54:55]
    s_waitcnt lgkmcnt(12)
    v_pk_add_f32 v[28:29], v[28:29], v[56:57]
    v_pk_add_f32 v[30:31], v[30:31], v[58:59]
    v_pk_add_f32 v[28:29], v[28:29], v[60:61]
    v_pk_add_f32 v[30:31], v[30:31], v[62:63]
    s_waitcnt lgkmcnt(10)
    v_pk_add_f32 v[28:29], v[28:29], v[64:65]
    v_pk_add_f32 v[30:31], v[30:31], v[66:67]
    v_pk_add_f32 v[28:29], v[28:29], v[68:69]
    v_pk_add_f32 v[30:31], v[30:31], v[70:71]
    s_waitcnt lgkmcnt(8)
    v_pk_add_f32 v[28:29], v[28:29], v[72:73]
    v_pk_add_f32 v[30:31], v[30:31], v[74:75]
    v_pk_add_f32 v[28:29], v[28:29], v[76:77]
    v_pk_add_f32 v[30:31], v[30:31], v[78:79]
    s_mov_b32 s77, 0
    buffer_store_dwordx4 v[28:31], v3, s[44:47], s77 offen
    s_waitcnt lgkmcnt(6)
    v_pk_add_f32 v[32:33], v[32:33], v[80:81]
    v_pk_add_f32 v[34:35], v[34:35], v[82:83]
    v_pk_add_f32 v[32:33], v[32:33], v[84:85]
    v_pk_add_f32 v[34:35], v[34:35], v[86:87]
    s_waitcnt lgkmcnt(4)
    v_pk_add_f32 v[32:33], v[32:33], v[88:89]
    v_pk_add_f32 v[34:35], v[34:35], v[90:91]
    v_pk_add_f32 v[32:33], v[32:33], v[92:93]
    v_pk_add_f32 v[34:35], v[34:35], v[94:95]
    s_waitcnt lgkmcnt(2)
    v_pk_add_f32 v[32:33], v[32:33], v[96:97]
    v_pk_add_f32 v[34:35], v[34:35], v[98:99]
    v_pk_add_f32 v[32:33], v[32:33], v[100:101]
    v_pk_add_f32 v[34:35], v[34:35], v[102:103]
    s_waitcnt lgkmcnt(0)
    v_pk_add_f32 v[32:33], v[32:33], v[104:105]
    v_pk_add_f32 v[34:35], v[34:35], v[106:107]
    v_pk_add_f32 v[32:33], v[32:33], v[108:109]
    v_pk_add_f32 v[34:35], v[34:35], v[110:111]
    s_mov_b32 s77, 28672
    buffer_store_dwordx4 v[32:35], v3, s[44:47], s77 offen
K1_RE:
    s_endpgm
K1_PREP:
    s_sub_u32 s70, s2, 224
    s_lshl_b32 s65, s64, 5
    s_add_u32 s65, s65, s70
    s_lshl_b32 s70, s70, 3
    s_add_u32 s70, s70, s64
    s_mov_b32 s60, s30
    s_and_b32 s61, s31, 0xffff
    s_mov_b32 s62, 896
    s_mov_b32 s63, 0x20000
    v_lshrrev_b32 v2, 3, v1
    s_lshl_b32 s71, s70, 3
    v_add_u32 v2, s71, v2
    v_and_b32 v3, 7, v1
    v_lshlrev_b32 v3, 4, v3
    v_mul_u32_u24 v4, 896, v2
    v_add_u32 v4, v4, v3
    v_lshlrev_b32 v5, 4, v1
    v_and_b32 v122, 7, v1
    v_lshlrev_b32 v122, 7, v122
    s_mov_b32 s38, 13541376
    s_cmp_ge_u32 s65, 224
    s_cbranch_scc1 K1_PN
    s_cmp_ge_u32 s65, 112
    s_cbranch_scc1 K1_PC
    s_mov_b32 s48, s28
    s_and_b32 s49, s29, 0xffff
    s_mov_b32 s50, 1605632
    s_mov_b32 s51, 0x20000
    s_mul_i32 s71, s65, 14336
    s_mul_i32 s72, s64, 14336
    s_add_u32 m0, s72, 0
    s_add_u32 s73, s71, 0
    buffer_load_dwordx4 v5, s[48:51], s73 offen lds
    s_add_u32 m0, s72, 1024
    s_add_u32 s73, s71, 1024
    buffer_load_dwordx4 v5, s[48:51], s73 offen lds
    s_add_u32 m0, s72, 2048
    s_add_u32 s73, s71, 2048
    buffer_load_dwordx4 v5, s[48:51], s73 offen lds
    s_add_u32 m0, s72, 3072
    s_add_u32 s73, s71, 3072
    buffer_load_dwordx4 v5, s[48:51], s73 offen lds
    s_add_u32 m0, s72, 4096
    s_add_u32 s73, s71, 4096
    buffer_load_dwordx4 v5, s[48:51], s73 offen lds
    s_add_u32 m0, s72, 5120
    s_add_u32 s73, s71, 5120
    buffer_load_dwordx4 v5, s[48:51], s73 offen lds
    s_add_u32 m0, s72, 6144
    s_add_u32 s73, s71, 6144
    buffer_load_dwordx4 v5, s[48:51], s73 offen lds
    s_add_u32 m0, s72, 7168
    s_add_u32 s73, s71, 7168
    buffer_load_dwordx4 v5, s[48:51], s73 offen lds
    s_add_u32 m0, s72, 8192
    s_add_u32 s73, s71, 8192
    buffer_load_dwordx4 v5, s[48:51], s73 offen lds
    s_add_u32 m0, s72, 9216
    s_add_u32 s73, s71, 9216
    buffer_load_dwordx4 v5, s[48:51], s73 offen lds
    s_add_u32 m0, s72, 10240
    s_add_u32 s73, s71, 10240
    buffer_load_dwordx4 v5, s[48:51], s73 offen lds
    s_add_u32 m0, s72, 11264
    s_add_u32 s73, s71, 11264
    buffer_load_dwordx4 v5, s[48:51], s73 offen lds
    s_add_u32 m0, s72, 12288
    s_add_u32 s73, s71, 12288
    buffer_load_dwordx4 v5, s[48:51], s73 offen lds
    s_add_u32 m0, s72, 13312
    s_add_u32 s73, s71, 13312
    buffer_load_dwordx4 v5, s[48:51], s73 offen lds
    v_lshrrev_b32 v6, 5, v1
    v_bfe_u32 v7, v1, 2, 2
    v_lshl_add_u32 v6, v6, 2, v7
    v_mul_u32_u24 v6, 896, v6
    v_bfe_u32 v7, v1, 4, 1
    v_lshl_add_u32 v6, v7, 5, v6
    v_and_b32 v7, 3, v1
    v_lshl_add_u32 v6, v7, 3, v6
    v_add_u32 v6, s72, v6
    s_lshl_b32 s71, s65, 10
    s_add_u32 s71, s71, 11010048
    s_waitcnt vmcnt(0)
    ds_read_b64_tr_b16 v[64:65], v6 offset:0
    ds_read_b64_tr_b16 v[66:67], v6 offset:7168
    ds_read_b64_tr_b16 v[68:69], v6 offset:64
    ds_read_b64_tr_b16 v[70:71], v6 offset:7232
    ds_read_b64_tr_b16 v[72:73], v6 offset:128
    ds_read_b64_tr_b16 v[74:75], v6 offset:7296
    ds_read_b64_tr_b16 v[76:77], v6 offset:192
    ds_read_b64_tr_b16 v[78:79], v6 offset:7360
    ds_read_b64_tr_b16 v[80:81], v6 offset:256
    ds_read_b64_tr_b16 v[82:83], v6 offset:7424
    ds_read_b64_tr_b16 v[84:85], v6 offset:320
    ds_read_b64_tr_b16 v[86:87], v6 offset:7488
    ds_read_b64_tr_b16 v[88:89], v6 offset:384
    ds_read_b64_tr_b16 v[90:91], v6 offset:7552
    ds_read_b64_tr_b16 v[92:93], v6 offset:448
    ds_read_b64_tr_b16 v[94:95], v6 offset:7616
    ds_read_b64_tr_b16 v[96:97], v6 offset:512
    ds_read_b64_tr_b16 v[98:99], v6 offset:7680
    ds_read_b64_tr_b16 v[100:101], v6 offset:576
    ds_read_b64_tr_b16 v[102:103], v6 offset:7744
    ds_read_b64_tr_b16 v[104:105], v6 offset:640
    ds_read_b64_tr_b16 v[106:107], v6 offset:7808
    ds_read_b64_tr_b16 v[108:109], v6 offset:704
    ds_read_b64_tr_b16 v[110:111], v6 offset:7872
    ds_read_b64_tr_b16 v[112:113], v6 offset:768
    ds_read_b64_tr_b16 v[114:115], v6 offset:7936
    ds_read_b64_tr_b16 v[116:117], v6 offset:832
    ds_read_b64_tr_b16 v[118:119], v6 offset:8000
    s_waitcnt lgkmcnt(0)
    buffer_store_dwordx4 v[64:67], v5, s[52:55], s71 offen sc1
    s_add_u32 s71, s71, 172032
    buffer_store_dwordx4 v[68:71], v5, s[52:55], s71 offen sc1
    s_add_u32 s71, s71, 172032
    buffer_store_dwordx4 v[72:75], v5, s[52:55], s71 offen sc1
    s_add_u32 s71, s71, 172032
    buffer_store_dwordx4 v[76:79], v5, s[52:55], s71 offen sc1
    s_add_u32 s71, s71, 172032
    buffer_store_dwordx4 v[80:83], v5, s[52:55], s71 offen sc1
    s_add_u32 s71, s71, 172032
    buffer_store_dwordx4 v[84:87], v5, s[52:55], s71 offen sc1
    s_add_u32 s71, s71, 172032
    buffer_store_dwordx4 v[88:91], v5, s[52:55], s71 offen sc1
    s_add_u32 s71, s71, 172032
    buffer_store_dwordx4 v[92:95], v5, s[52:55], s71 offen sc1
    s_add_u32 s71, s71, 172032
    buffer_store_dwordx4 v[96:99], v5, s[52:55], s71 offen sc1
    s_add_u32 s71, s71, 172032
    buffer_store_dwordx4 v[100:103], v5, s[52:55], s71 offen sc1
    s_add_u32 s71, s71, 172032
    buffer_store_dwordx4 v[104:107], v5, s[52:55], s71 offen sc1
    s_add_u32 s71, s71, 172032
    buffer_store_dwordx4 v[108:111], v5, s[52:55], s71 offen sc1
    s_add_u32 s71, s71, 172032
    buffer_store_dwordx4 v[112:115], v5, s[52:55], s71 offen sc1
    s_add_u32 s71, s71, 172032
    buffer_store_dwordx4 v[116:119], v5, s[52:55], s71 offen sc1
    s_add_u32 s71, s71, 172032
    s_branch K1_PG
K1_PC:
    s_sub_u32 s66, s65, 112
    s_lshr_b32 s67, s66, 3
    s_bfe_u32 s68, s66, 0x10002
    s_and_b32 s69, s66, 3
    s_cmp_eq_u32 s68, 0
    s_cselect_b32 s44, s14, s16
    s_cselect_b32 s45, s15, s17
    s_and_b32 s45, s45, 0xffff
    s_mov_b32 s46, 401408
    s_mov_b32 s47, 0x20000
    v_and_b32 v6, 31, v1
    s_lshl_b32 s71, s67, 5
    v_add_u32 v6, s71, v6
    v_mul_u32_u24 v6, 896, v6
    v_lshrrev_b32 v7, 5, v1
    v_lshl_add_u32 v6, v7, 4, v6
    s_mul_i32 s69, s69, 7
    s_lshl_b32 s71, s69, 5
    buffer_load_dwordx4 v[64:67], v6, s[44:47], s71 offen offset:0
    buffer_load_dwordx4 v[68:71], v6, s[44:47], s71 offen offset:32
    buffer_load_dwordx4 v[72:75], v6, s[44:47], s71 offen offset:64
    buffer_load_dwordx4 v[76:79], v6, s[44:47], s71 offen offset:96
    buffer_load_dwordx4 v[80:83], v6, s[44:47], s71 offen offset:128
    buffer_load_dwordx4 v[84:87], v6, s[44:47], s71 offen offset:160
    buffer_load_dwordx4 v[88:91], v6, s[44:47], s71 offen offset:192
    s_mul_i32 s72, s67, 168
    s_lshl_b32 s68, s68, 1
    s_add_u32 s72, s72, s68
    s_add_u32 s72, s72, 10864
    s_waitcnt vmcnt(0)
    s_add_u32 s73, s69, 0
    s_lshr_b32 s74, s73, 1
    s_lshl_b32 s74, s74, 2
    s_and_b32 s73, s73, 1
    s_add_u32 s73, s73, s74
    s_add_u32 s73, s73, s72
    s_lshl_b32 s73, s73, 10
    buffer_store_dwordx4 v[64:67], v5, s[52:55], s73 offen sc1
    s_add_u32 s73, s69, 1
    s_lshr_b32 s74, s73, 1
    s_lshl_b32 s74, s74, 2
    s_and_b32 s73, s73, 1
    s_add_u32 s73, s73, s74
    s_add_u32 s73, s73, s72
    s_lshl_b32 s73, s73, 10
    buffer_store_dwordx4 v[68:71], v5, s[52:55], s73 offen sc1
    s_add_u32 s73, s69, 2
    s_lshr_b32 s74, s73, 1
    s_lshl_b32 s74, s74, 2
    s_and_b32 s73, s73, 1
    s_add_u32 s73, s73, s74
    s_add_u32 s73, s73, s72
    s_lshl_b32 s73, s73, 10
    buffer_store_dwordx4 v[72:75], v5, s[52:55], s73 offen sc1
    s_add_u32 s73, s69, 3
    s_lshr_b32 s74, s73, 1
    s_lshl_b32 s74, s74, 2
    s_and_b32 s73, s73, 1
    s_add_u32 s73, s73, s74
    s_add_u32 s73, s73, s72
    s_lshl_b32 s73, s73, 10
    buffer_store_dwordx4 v[76:79], v5, s[52:55], s73 offen sc1
    s_add_u32 s73, s69, 4
    s_lshr_b32 s74, s73, 1
    s_lshl_b32 s74, s74, 2
    s_and_b32 s73, s73, 1
    s_add_u32 s73, s73, s74
    s_add_u32 s73, s73, s72
    s_lshl_b32 s73, s73, 10
    buffer_store_dwordx4 v[80:83], v5, s[52:55], s73 offen sc1
    s_add_u32 s73, s69, 5
    s_lshr_b32 s74, s73, 1
    s_lshl_b32 s74, s74, 2
    s_and_b32 s73, s73, 1
    s_add_u32 s73, s73, s74
    s_add_u32 s73, s73, s72
    s_lshl_b32 s73, s73, 10
    buffer_store_dwordx4 v[84:87], v5, s[52:55], s73 offen sc1
    s_add_u32 s73, s69, 6
    s_lshr_b32 s74, s73, 1
    s_lshl_b32 s74, s74, 2
    s_and_b32 s73, s73, 1
    s_add_u32 s73, s73, s74
    s_add_u32 s73, s73, s72
    s_lshl_b32 s73, s73, 10
    buffer_store_dwordx4 v[88:91], v5, s[52:55], s73 offen sc1
    s_branch K1_PG
K1_PN:
    s_mov_b32 s56, s34
    s_and_b32 s57, s35, 0xffff
    s_mov_b32 s58, 256
    s_mov_b32 s59, 0x20000
    v_mov_b32 v44, 0
    s_mov_b32 s71, 13541376
    s_cmp_lg_u32 s2, 224
    s_cbranch_scc1 K1_PN1
    buffer_load_dword v42, v44, s[52:55], s71 offen sc1
    v_and_b32 v44, 1, v1
    v_lshlrev_b32 v44, 7, v44
    v_mov_b32 v43, 1
    s_waitcnt vmcnt(0)
    v_add_u32 v42, 0x9e3779b9, v42
    buffer_store_dwordx2 v[42:43], v44, s[56:59], 0 offen sc1
    s_branch K1_PN2
K1_PN1:
    s_mov_b32 s81, 0
POLL4:
    buffer_load_dwordx2 v[42:43], v44, s[56:59], 0 offen sc1
    s_waitcnt vmcnt(0)
    v_cmp_eq_u32 vcc, 1, v43
    s_nop 4
    s_andn2_b32 s71, -1, vcc_lo
    s_cbranch_scc0 POLLD4
    s_add_u32 s81, s81, 1
    s_cmp_gt_u32 s81, 0x10000
    s_cbranch_scc1 POLLD4
    s_sleep 1
    s_branch POLL4
POLLD4:
K1_PN2:
    v_mov_b32 v123, v42
    s_sub_u32 s38, s2, 224
    s_lshl_b32 s38, s38, 2
    s_add_u32 s38, s38, 13541376
K1_PG:
    buffer_load_dwordx4 v[8:11], v4, s[40:43], 0 offen offset:0
    buffer_load_dwordx4 v[36:39], v3, s[60:63], 0 offen offset:0
    buffer_load_dwordx4 v[12:15], v4, s[40:43], 0 offen offset:128
    buffer_load_dwordx4 v[40:43], v3, s[60:63], 0 offen offset:128
    buffer_load_dwordx4 v[16:19], v4, s[40:43], 0 offen offset:256
    buffer_load_dwordx4 v[44:47], v3, s[60:63], 0 offen offset:256
    buffer_load_dwordx4 v[20:23], v4, s[40:43], 0 offen offset:384
    buffer_load_dwordx4 v[48:51], v3, s[60:63], 0 offen offset:384
    buffer_load_dwordx4 v[24:27], v4, s[40:43], 0 offen offset:512
    buffer_load_dwordx4 v[52:55], v3, s[60:63], 0 offen offset:512
    buffer_load_dwordx4 v[28:31], v4, s[40:43], 0 offen offset:640
    buffer_load_dwordx4 v[56:59], v3, s[60:63], 0 offen offset:640
    buffer_load_dwordx4 v[32:35], v4, s[40:43], 0 offen offset:768
    buffer_load_dwordx4 v[60:63], v3, s[60:63], 0 offen offset:768
    s_waitcnt vmcnt(14)
    s_barrier
    s_cmp_lg_u32 s64, 7
    s_cbranch_scc1 K1_PF
    buffer_store_dword v123, v122, s[52:55], s38 offen sc1
K1_PF:
    s_waitcnt vmcnt(0)
    v_mov_b32 v6, 0
    v_mov_b32 v7, 0
    s_mov_b32 s71, 0xffff0000
    v_lshlrev_b32 v124, 16, v8
    v_and_b32 v125, s71, v8
    v_lshlrev_b32 v126, 16, v36
    v_and_b32 v127, s71, v36
    v_mul_f32 v124, v124, v126
    v_mul_f32 v125, v125, v127
    v_cvt_pk_bf16_f32 v124, v124, v125
    v_lshlrev_b32 v125, 16, v124
    v_and_b32 v124, s71, v124
    v_add_f32 v6, v6, v125
    v_add_f32 v7, v7, v124
    v_lshlrev_b32 v124, 16, v9
    v_and_b32 v125, s71, v9
    v_lshlrev_b32 v126, 16, v37
    v_and_b32 v127, s71, v37
    v_mul_f32 v124, v124, v126
    v_mul_f32 v125, v125, v127
    v_cvt_pk_bf16_f32 v124, v124, v125
    v_lshlrev_b32 v125, 16, v124
    v_and_b32 v124, s71, v124
    v_add_f32 v6, v6, v125
    v_add_f32 v7, v7, v124
    v_lshlrev_b32 v124, 16, v10
    v_and_b32 v125, s71, v10
    v_lshlrev_b32 v126, 16, v38
    v_and_b32 v127, s71, v38
    v_mul_f32 v124, v124, v126
    v_mul_f32 v125, v125, v127
    v_cvt_pk_bf16_f32 v124, v124, v125
    v_lshlrev_b32 v125, 16, v124
    v_and_b32 v124, s71, v124
    v_add_f32 v6, v6, v125
    v_add_f32 v7, v7, v124
    v_lshlrev_b32 v124, 16, v11
    v_and_b32 v125, s71, v11
    v_lshlrev_b32 v126, 16, v39
    v_and_b32 v127, s71, v39
    v_mul_f32 v124, v124, v126
    v_mul_f32 v125, v125, v127
    v_cvt_pk_bf16_f32 v124, v124, v125
    v_lshlrev_b32 v125, 16, v124
    v_and_b32 v124, s71, v124
    v_add_f32 v6, v6, v125
    v_add_f32 v7, v7, v124
    v_lshlrev_b32 v124, 16, v12
    v_and_b32 v125, s71, v12
    v_lshlrev_b32 v126, 16, v40
    v_and_b32 v127, s71, v40
    v_mul_f32 v124, v124, v126
    v_mul_f32 v125, v125, v127
    v_cvt_pk_bf16_f32 v124, v124, v125
    v_lshlrev_b32 v125, 16, v124
    v_and_b32 v124, s71, v124
    v_add_f32 v6, v6, v125
    v_add_f32 v7, v7, v124
    v_lshlrev_b32 v124, 16, v13
    v_and_b32 v125, s71, v13
    v_lshlrev_b32 v126, 16, v41
    v_and_b32 v127, s71, v41
    v_mul_f32 v124, v124, v126
    v_mul_f32 v125, v125, v127
    v_cvt_pk_bf16_f32 v124, v124, v125
    v_lshlrev_b32 v125, 16, v124
    v_and_b32 v124, s71, v124
    v_add_f32 v6, v6, v125
    v_add_f32 v7, v7, v124
    v_lshlrev_b32 v124, 16, v14
    v_and_b32 v125, s71, v14
    v_lshlrev_b32 v126, 16, v42
    v_and_b32 v127, s71, v42
    v_mul_f32 v124, v124, v126
    v_mul_f32 v125, v125, v127
    v_cvt_pk_bf16_f32 v124, v124, v125
    v_lshlrev_b32 v125, 16, v124
    v_and_b32 v124, s71, v124
    v_add_f32 v6, v6, v125
    v_add_f32 v7, v7, v124
    v_lshlrev_b32 v124, 16, v15
    v_and_b32 v125, s71, v15
    v_lshlrev_b32 v126, 16, v43
    v_and_b32 v127, s71, v43
    v_mul_f32 v124, v124, v126
    v_mul_f32 v125, v125, v127
    v_cvt_pk_bf16_f32 v124, v124, v125
    v_lshlrev_b32 v125, 16, v124
    v_and_b32 v124, s71, v124
    v_add_f32 v6, v6, v125
    v_add_f32 v7, v7, v124
    v_lshlrev_b32 v124, 16, v16
    v_and_b32 v125, s71, v16
    v_lshlrev_b32 v126, 16, v44
    v_and_b32 v127, s71, v44
    v_mul_f32 v124, v124, v126
    v_mul_f32 v125, v125, v127
    v_cvt_pk_bf16_f32 v124, v124, v125
    v_lshlrev_b32 v125, 16, v124
    v_and_b32 v124, s71, v124
    v_add_f32 v6, v6, v125
    v_add_f32 v7, v7, v124
    v_lshlrev_b32 v124, 16, v17
    v_and_b32 v125, s71, v17
    v_lshlrev_b32 v126, 16, v45
    v_and_b32 v127, s71, v45
    v_mul_f32 v124, v124, v126
    v_mul_f32 v125, v125, v127
    v_cvt_pk_bf16_f32 v124, v124, v125
    v_lshlrev_b32 v125, 16, v124
    v_and_b32 v124, s71, v124
    v_add_f32 v6, v6, v125
    v_add_f32 v7, v7, v124
    v_lshlrev_b32 v124, 16, v18
    v_and_b32 v125, s71, v18
    v_lshlrev_b32 v126, 16, v46
    v_and_b32 v127, s71, v46
    v_mul_f32 v124, v124, v126
    v_mul_f32 v125, v125, v127
    v_cvt_pk_bf16_f32 v124, v124, v125
    v_lshlrev_b32 v125, 16, v124
    v_and_b32 v124, s71, v124
    v_add_f32 v6, v6, v125
    v_add_f32 v7, v7, v124
    v_lshlrev_b32 v124, 16, v19
    v_and_b32 v125, s71, v19
    v_lshlrev_b32 v126, 16, v47
    v_and_b32 v127, s71, v47
    v_mul_f32 v124, v124, v126
    v_mul_f32 v125, v125, v127
    v_cvt_pk_bf16_f32 v124, v124, v125
    v_lshlrev_b32 v125, 16, v124
    v_and_b32 v124, s71, v124
    v_add_f32 v6, v6, v125
    v_add_f32 v7, v7, v124
    v_lshlrev_b32 v124, 16, v20
    v_and_b32 v125, s71, v20
    v_lshlrev_b32 v126, 16, v48
    v_and_b32 v127, s71, v48
    v_mul_f32 v124, v124, v126
    v_mul_f32 v125, v125, v127
    v_cvt_pk_bf16_f32 v124, v124, v125
    v_lshlrev_b32 v125, 16, v124
    v_and_b32 v124, s71, v124
    v_add_f32 v6, v6, v125
    v_add_f32 v7, v7, v124
    v_lshlrev_b32 v124, 16, v21
    v_and_b32 v125, s71, v21
    v_lshlrev_b32 v126, 16, v49
    v_and_b32 v127, s71, v49
    v_mul_f32 v124, v124, v126
    v_mul_f32 v125, v125, v127
    v_cvt_pk_bf16_f32 v124, v124, v125
    v_lshlrev_b32 v125, 16, v124
    v_and_b32 v124, s71, v124
    v_add_f32 v6, v6, v125
    v_add_f32 v7, v7, v124
    v_lshlrev_b32 v124, 16, v22
    v_and_b32 v125, s71, v22
    v_lshlrev_b32 v126, 16, v50
    v_and_b32 v127, s71, v50
    v_mul_f32 v124, v124, v126
    v_mul_f32 v125, v125, v127
    v_cvt_pk_bf16_f32 v124, v124, v125
    v_lshlrev_b32 v125, 16, v124
    v_and_b32 v124, s71, v124
    v_add_f32 v6, v6, v125
    v_add_f32 v7, v7, v124
    v_lshlrev_b32 v124, 16, v23
    v_and_b32 v125, s71, v23
    v_lshlrev_b32 v126, 16, v51
    v_and_b32 v127, s71, v51
    v_mul_f32 v124, v124, v126
    v_mul_f32 v125, v125, v127
    v_cvt_pk_bf16_f32 v124, v124, v125
    v_lshlrev_b32 v125, 16, v124
    v_and_b32 v124, s71, v124
    v_add_f32 v6, v6, v125
    v_add_f32 v7, v7, v124
    v_lshlrev_b32 v124, 16, v24
    v_and_b32 v125, s71, v24
    v_lshlrev_b32 v126, 16, v52
    v_and_b32 v127, s71, v52
    v_mul_f32 v124, v124, v126
    v_mul_f32 v125, v125, v127
    v_cvt_pk_bf16_f32 v124, v124, v125
    v_lshlrev_b32 v125, 16, v124
    v_and_b32 v124, s71, v124
    v_add_f32 v6, v6, v125
    v_add_f32 v7, v7, v124
    v_lshlrev_b32 v124, 16, v25
    v_and_b32 v125, s71, v25
    v_lshlrev_b32 v126, 16, v53
    v_and_b32 v127, s71, v53
    v_mul_f32 v124, v124, v126
    v_mul_f32 v125, v125, v127
    v_cvt_pk_bf16_f32 v124, v124, v125
    v_lshlrev_b32 v125, 16, v124
    v_and_b32 v124, s71, v124
    v_add_f32 v6, v6, v125
    v_add_f32 v7, v7, v124
    v_lshlrev_b32 v124, 16, v26
    v_and_b32 v125, s71, v26
    v_lshlrev_b32 v126, 16, v54
    v_and_b32 v127, s71, v54
    v_mul_f32 v124, v124, v126
    v_mul_f32 v125, v125, v127
    v_cvt_pk_bf16_f32 v124, v124, v125
    v_lshlrev_b32 v125, 16, v124
    v_and_b32 v124, s71, v124
    v_add_f32 v6, v6, v125
    v_add_f32 v7, v7, v124
    v_lshlrev_b32 v124, 16, v27
    v_and_b32 v125, s71, v27
    v_lshlrev_b32 v126, 16, v55
    v_and_b32 v127, s71, v55
    v_mul_f32 v124, v124, v126
    v_mul_f32 v125, v125, v127
    v_cvt_pk_bf16_f32 v124, v124, v125
    v_lshlrev_b32 v125, 16, v124
    v_and_b32 v124, s71, v124
    v_add_f32 v6, v6, v125
    v_add_f32 v7, v7, v124
    v_lshlrev_b32 v124, 16, v28
    v_and_b32 v125, s71, v28
    v_lshlrev_b32 v126, 16, v56
    v_and_b32 v127, s71, v56
    v_mul_f32 v124, v124, v126
    v_mul_f32 v125, v125, v127
    v_cvt_pk_bf16_f32 v124, v124, v125
    v_lshlrev_b32 v125, 16, v124
    v_and_b32 v124, s71, v124
    v_add_f32 v6, v6, v125
    v_add_f32 v7, v7, v124
    v_lshlrev_b32 v124, 16, v29
    v_and_b32 v125, s71, v29
    v_lshlrev_b32 v126, 16, v57
    v_and_b32 v127, s71, v57
    v_mul_f32 v124, v124, v126
    v_mul_f32 v125, v125, v127
    v_cvt_pk_bf16_f32 v124, v124, v125
    v_lshlrev_b32 v125, 16, v124
    v_and_b32 v124, s71, v124
    v_add_f32 v6, v6, v125
    v_add_f32 v7, v7, v124
    v_lshlrev_b32 v124, 16, v30
    v_and_b32 v125, s71, v30
    v_lshlrev_b32 v126, 16, v58
    v_and_b32 v127, s71, v58
    v_mul_f32 v124, v124, v126
    v_mul_f32 v125, v125, v127
    v_cvt_pk_bf16_f32 v124, v124, v125
    v_lshlrev_b32 v125, 16, v124
    v_and_b32 v124, s71, v124
    v_add_f32 v6, v6, v125
    v_add_f32 v7, v7, v124
    v_lshlrev_b32 v124, 16, v31
    v_and_b32 v125, s71, v31
    v_lshlrev_b32 v126, 16, v59
    v_and_b32 v127, s71, v59
    v_mul_f32 v124, v124, v126
    v_mul_f32 v125, v125, v127
    v_cvt_pk_bf16_f32 v124, v124, v125
    v_lshlrev_b32 v125, 16, v124
    v_and_b32 v124, s71, v124
    v_add_f32 v6, v6, v125
    v_add_f32 v7, v7, v124
    v_lshlrev_b32 v124, 16, v32
    v_and_b32 v125, s71, v32
    v_lshlrev_b32 v126, 16, v60
    v_and_b32 v127, s71, v60
    v_mul_f32 v124, v124, v126
    v_mul_f32 v125, v125, v127
    v_cvt_pk_bf16_f32 v124, v124, v125
    v_lshlrev_b32 v125, 16, v124
    v_and_b32 v124, s71, v124
    v_add_f32 v6, v6, v125
    v_add_f32 v7, v7, v124
    v_lshlrev_b32 v124, 16, v33
    v_and_b32 v125, s71, v33
    v_lshlrev_b32 v126, 16, v61
    v_and_b32 v127, s71, v61
    v_mul_f32 v124, v124, v126
    v_mul_f32 v125, v125, v127
    v_cvt_pk_bf16_f32 v124, v124, v125
    v_lshlrev_b32 v125, 16, v124
    v_and_b32 v124, s71, v124
    v_add_f32 v6, v6, v125
    v_add_f32 v7, v7, v124
    v_lshlrev_b32 v124, 16, v34
    v_and_b32 v125, s71, v34
    v_lshlrev_b32 v126, 16, v62
    v_and_b32 v127, s71, v62
    v_mul_f32 v124, v124, v126
    v_mul_f32 v125, v125, v127
    v_cvt_pk_bf16_f32 v124, v124, v125
    v_lshlrev_b32 v125, 16, v124
    v_and_b32 v124, s71, v124
    v_add_f32 v6, v6, v125
    v_add_f32 v7, v7, v124
    v_lshlrev_b32 v124, 16, v35
    v_and_b32 v125, s71, v35
    v_lshlrev_b32 v126, 16, v63
    v_and_b32 v127, s71, v63
    v_mul_f32 v124, v124, v126
    v_mul_f32 v125, v125, v127
    v_cvt_pk_bf16_f32 v124, v124, v125
    v_lshlrev_b32 v125, 16, v124
    v_and_b32 v124, s71, v124
    v_add_f32 v6, v6, v125
    v_add_f32 v7, v7, v124
    v_add_f32 v6, v6, v7
    ds_swizzle_b32 v7, v6 offset:0x041F
    s_waitcnt lgkmcnt(0)
    v_add_f32 v6, v6, v7
    ds_swizzle_b32 v7, v6 offset:0x081F
    s_waitcnt lgkmcnt(0)
    v_add_f32 v6, v6, v7
    ds_swizzle_b32 v7, v6 offset:0x101F
    s_waitcnt lgkmcnt(0)
    v_add_f32 v6, v6, v7
    v_cvt_pk_bf16_f32 v6, v6, v6
    v_lshlrev_b32 v6, 16, v6
    v_mul_f32 v6, 0xbfb8aa3b, v6
    v_exp_f32 v6, v6
    s_nop 0
    v_add_f32 v6, 1.0, v6
    v_rcp_f32 v6, v6
    s_nop 0
    v_cvt_pk_bf16_f32 v6, v6, v6
    v_lshlrev_b32 v6, 16, v6
    v_lshlrev_b32 v2, 2, v2
    s_mov_b32 s71, 13418496
    buffer_store_dword v6, v2, s[52:55], s71 offen sc1
    s_waitcnt vmcnt(0)
    s_barrier
    s_cmp_lg_u32 s64, 7
    s_cbranch_scc1 K1_PE
    buffer_store_dword v123, v122, s[52:55], s38 offen offset:1024 sc1
K1_PE:
K1_END:
    s_endpgm
.section .rodata,"a"
.p2align 6
.amdhsa_kernel gated_mix__ssm_conv_s5__glu_gated_geglu__prompt_kernel
  .amdhsa_next_free_vgpr 256
  .amdhsa_next_free_sgpr 96
  .amdhsa_accum_offset 256
  .amdhsa_group_segment_fixed_size 0
  .amdhsa_kernarg_size 136
  .amdhsa_user_sgpr_count 2
  .amdhsa_user_sgpr_kernarg_segment_ptr 1
  .amdhsa_system_sgpr_workgroup_id_x 1
.end_amdhsa_kernel
```
